```python
import torch

def _softmax(x, axis=-1):
    return torch.softmax(x, dim=axis)
def _gelu(x):
    return torch.nn.functional.gelu(x, approximate="tanh")
def _silu(x):
    return torch.nn.functional.silu(x)
def _sigmoid(x):
    return torch.sigmoid(x)
def _layernorm(x, axis=-1, eps=1e-5):
    m = x.mean(dim=axis, keepdim=True)
    v = x.var(dim=axis, keepdim=True, unbiased=False)
    return (x - m) / torch.sqrt(v + eps)
def _scatter_add(tgt, idx, src, axis=0):
    return tgt.clone().index_add_(axis, idx, src)
def _segment_sum(src, seg, n):
    out = torch.zeros((n,) + src.shape[1:], dtype=src.dtype)
    return out.index_add_(0, seg, src)
def _pad(x, pw):
    flat = tuple(v for pair in reversed(pw) for v in pair)
    return torch.nn.functional.pad(x, flat)

kernel_name = 'sequential_preLN__mha_block__moe_arch_mod__prompt'

def setup_inputs():

    _w = (lambda a: (lambda t: t.to(torch.bfloat16) if t.is_floating_point() else t)(torch.as_tensor(a)))
    def _A_setup():
        B, S, D, H = 1, 2048, 448, 16
        return {
            "x": _w((lambda *s: torch.randn(*s, dtype=torch.bfloat16) * 0.05)(B, S, D)),
            "wqkv": _w((lambda *s: torch.randn(*s, dtype=torch.bfloat16) * 0.05)(D, 3 * D)),
            "wo": _w((lambda *s: torch.randn(*s, dtype=torch.bfloat16) * 0.05)(D, D)),
        }
    _A_in = _A_setup()

    def _B_setup():
        B, S, D, F, C = 1, 2048, 448, 1792, 8
        return {
            "x": _w((lambda *s: torch.randn(*s, dtype=torch.bfloat16) * 0.05)(B, S, D)),
            "w_r": _w((lambda *s: torch.randn(*s, dtype=torch.bfloat16) * 0.05)(D)),
            "w_gate": _w((lambda *s: torch.randn(*s, dtype=torch.bfloat16) * 0.05)(D, F)),
            "w_up": _w((lambda *s: torch.randn(*s, dtype=torch.bfloat16) * 0.05)(D, F)),
            "w_down": _w((lambda *s: torch.randn(*s, dtype=torch.bfloat16) * 0.05)(F, D)),
        }
    _B_in = _B_setup()

    return {
        "A_x": _A_in["x"],
        "A_wqkv": _A_in["wqkv"],
        "A_wo": _A_in["wo"],
        "B_x": _B_in["x"],
        "B_w_r": _B_in["w_r"],
        "B_w_gate": _B_in["w_gate"],
        "B_w_up": _B_in["w_up"],
        "B_w_down": _B_in["w_down"],
    }

def reference(A_x, A_wqkv, A_wo, B_x, B_w_r, B_w_gate, B_w_up, B_w_down):
    def _A_ref(x, wqkv, wo):
        B, S, D = x.shape
        H = 16
        Dh = D // H
        qkv = (lambda x, *d: x.permute(*d))((x @ wqkv).reshape(B, S, 3, H, Dh), 2, 0, 3, 1, 4)
        q, k, v = qkv[0], qkv[1], qkv[2]
        scores = torch.einsum("bhqd,bhkd->bhqk", q, k) * (Dh ** -0.5)
        p = _softmax(scores, axis=-1)
        o = torch.einsum("bhqk,bhkd->bhqd", p, v)
        return (lambda x, *d: x.permute(*d))(o, 0, 2, 1, 3).reshape(B, S, D) @ wo

    def _B_ref(x, w_r, w_gate, w_up, w_down):
        B, S, D = x.shape
        C = 8
        r = x @ w_r
        idx = torch.argsort(-r, axis=-1)[:, :C]
        idx_e = (lambda x, n, axis: torch.repeat_interleave(x, n, dim=axis))(idx.reshape(B, C, 1), D, axis=2)
        x_sel = (lambda x, i, axis: torch.take_along_dim(x, i, dim=axis))(x, idx_e, axis=1)
        g = _silu(x_sel @ w_gate)
        u = x_sel @ w_up
        y = (g * u) @ w_down
        r_sel = _sigmoid((lambda x, i, axis: torch.take_along_dim(x, i, dim=axis))(r, idx, axis=1))
        y = y * r_sel.reshape(B, C, 1)
        b_off = (torch.arange(B) * S).reshape(B, 1)
        flat_idx = (idx + b_off).reshape(B * C)
        zero = (x * 0.0).reshape(B * S, D)
        upd = _scatter_add(zero, flat_idx, y.reshape(B * C, D), axis=0)
        return x + upd.reshape(B, S, D)

    x = A_x
    h = x + _A_ref(_layernorm(x, axis=-1), A_wqkv, A_wo)
    h2 = h + _B_ref(_layernorm(h, axis=-1), B_w_r, B_w_gate, B_w_up, B_w_down)
    return h2
```

```asm
; @launch grid=(256,1,1) block=(512,1,1) lds=163840
.amdgcn_target "amdgcn-amd-amdhsa--gfx950"
.text
.globl sequential_preLN__mha_block__moe_arch_mod__prompt_kernel
.p2align 8
.type sequential_preLN__mha_block__moe_arch_mod__prompt_kernel,@function
sequential_preLN__mha_block__moe_arch_mod__prompt_kernel:
    s_cmp_ge_u32 s2, 256
    s_cbranch_scc1 L_end
    s_load_dwordx2 s[4:5], s[0:1], 0
    s_load_dwordx2 s[12:13], s[0:1], 8
    s_load_dwordx2 s[20:21], s[0:1], 80
    s_getpc_b64 s[70:71]
    v_lshrrev_b32 v9, 3, v0
    v_lshlrev_b32 v9, 7, v9
    global_load_dword v9, v9, s[70:71] offset:128
    v_lshrrev_b32 v10, 6, v0
    v_and_b32 v1, 63, v0
    v_readfirstlane_b32 s40, v10
    s_and_b32 s3, s2, 7
    s_lshr_b32 s51, s2, 3
    s_and_b32 s48, s51, 3
    s_lshr_b32 s45, s51, 2
    s_lshr_b32 s46, s3, 2
    s_and_b32 s44, s3, 3
    s_lshl_b32 s44, s44, 2
    s_add_u32 s44, s44, s48
    s_lshl_b32 s43, s46, 3
    s_add_u32 s43, s43, s45
    s_lshl_b32 s47, s3, 3
    s_add_u32 s47, s47, s45
    s_and_b32 s41, s40, 3
    s_lshr_b32 s42, s40, 2
    v_lshlrev_b32 v2, 4, v1
    v_and_b32 v3, 31, v0
    v_lshrrev_b32 v4, 5, v1
    v_lshrrev_b32 v11, 3, v1
    v_and_b32 v12, 7, v0
    s_lshl_b32 s52, s44, 7
    s_lshl_b32 s53, s40, 4
    s_add_u32 s52, s52, s53
    v_add_u32 v13, s52, v11
    v_mul_u32_u24 v13, 896, v13
    v_lshrrev_b32 v14, 1, v11
    v_xor_b32 v15, v12, v14
    v_lshl_add_u32 v5, v15, 4, v13
    v_xor_b32 v15, 4, v15
    v_lshl_add_u32 v6, v15, 4, v13
    v_add_u32 v6, 6144, v6
    s_lshl_b32 s52, s40, 3
    v_add_u32 v13, s52, v11
    v_mul_u32_u24 v13, 2688, v13
    v_and_b32 v14, 1, v14
    v_lshlrev_b32 v14, 2, v14
    v_xor_b32 v14, v12, v14
    v_lshl_add_u32 v7, v14, 4, v13
    s_add_u32 s59, s46, 1
    s_mul_i32 s59, s59, 896
    s_lshl_b32 s52, s45, 7
    s_add_u32 s59, s59, s52
    s_mov_b32 s6, 1835008
    s_mov_b32 s7, 0x20000
    s_mov_b32 s15, 0x20000
    s_cmp_lt_u32 s45, 7
    s_cselect_b32 s14, 1204224, 0
    s_lshl_b32 s56, s40, 11
    s_lshl_b32 s57, s40, 10
    s_add_u32 s57, s57, 114688
    s_mov_b32 s22, 16777216
    s_mov_b32 s23, 0x20000
    s_mov_b32 s81, s2
    s_cmp_lt_u32 s2, 16
    s_cselect_b32 s80, s40, 0
    s_waitcnt lgkmcnt(0)
    s_mov_b32 m0, s56
    s_nop 0
    buffer_load_dwordx4 v5, s[4:7], 0 offen offset:0 lds
    buffer_load_dwordx4 v6, s[4:7], 0 offen offset:1024 lds
    s_mov_b32 m0, s57
    s_nop 0
    buffer_load_dwordx4 v7, s[12:15], s59 offen lds
    s_load_dwordx2 s[16:17], s[0:1], 16
    s_load_dwordx2 s[32:33], s[0:1], 32
    s_load_dwordx4 s[76:79], s[0:1], 40
    s_load_dwordx2 s[82:83], s[0:1], 56
    s_load_dwordx2 s[24:25], s[0:1], 64
    s_load_dwordx2 s[28:29], s[0:1], 72
    s_cmp_eq_u32 s80, 7
    s_cbranch_scc0 L_1
    s_lshl_b32 s52, s81, 10
    s_add_u32 s52, s52, 8388608
    v_mov_b32 v12, 0
    v_mov_b32 v13, 0
    v_mov_b32 v14, 0
    v_mov_b32 v15, 0
    buffer_store_dwordx4 v[12:15], v2, s[20:23], s52 offen sc1
L_1:
    s_lshl_b32 s62, s42, 1
    s_xor_b32 s62, s41, s62
    v_bfe_u32 v10, v0, 1, 3
    v_xor_b32 v10, v10, v4
    s_lshl_b32 s53, s62, 1
    v_xor_b32 v10, s53, v10
    s_lshl_b32 s53, s41, 12
    v_lshl_add_u32 v11, v3, 7, s53
    v_lshl_add_u32 v16, v10, 4, v11
    v_bfe_u32 v12, v0, 2, 2
    v_bfe_u32 v13, v0, 3, 1
    v_xor_b32 v13, s42, v13
    v_lshlrev_b32 v13, 6, v13
    v_lshl_add_u32 v13, v12, 7, v13
    v_lshl_add_u32 v13, v4, 10, v13
    v_and_b32 v14, 16, v0
    v_and_b32 v15, 3, v0
    v_lshlrev_b32 v14, 1, v14
    v_lshl_add_u32 v14, v15, 3, v14
    s_lshl_b32 s54, s62, 11
    s_add_u32 s54, s54, 114688
    v_add3_u32 v20, v13, v14, s54
    v_xor_b32 v17, 32, v16
    v_xor_b32 v21, 0x800, v20
    v_xor_b32 v18, 64, v16
    v_xor_b32 v22, 0x1000, v20
    v_xor_b32 v19, 0x60, v16
    v_xor_b32 v23, 0x1800, v20
    v_lshl_add_u32 v14, v12, 6, v14
    v_lshl_add_u32 v24, v4, 9, v14
    v_mov_b32 v25, 0x3f803f80
    s_add_u32 m0, s56, 16256
    s_add_u32 s59, s59, 172032
    buffer_load_dwordx4 v5, s[4:7], 0 offen offset:128 lds
    buffer_load_dwordx4 v6, s[4:7], 0 offen offset:1152 lds
    s_add_u32 m0, s57, 8192
    s_nop 0
    buffer_load_dwordx4 v7, s[12:15], s59 offen lds
    v_mov_b32 v168, 0
    v_mov_b32 v169, 0
    v_mov_b32 v170, 0
    v_mov_b32 v171, 0
    v_lshrrev_b32 v10, 4, v0
    v_xor_b32 v10, v10, v0
    v_and_b32 v10, 1, v10
    v_add_u32 v10, -1, v10
    v_and_b32 v176, v25, v10
    v_and_b32 v177, v25, v10
    v_and_b32 v178, v25, v10
    v_and_b32 v179, v25, v10
    s_waitcnt lgkmcnt(0)
    s_cmp_eq_u32 s46, 1
    s_cbranch_scc1 L_vpass
    s_mov_b32 s8, s12
    s_mov_b32 s9, s13
    s_mov_b32 s10, 1204224
    s_mov_b32 s11, 0x20000
    s_mov_b32 s30, 256
    s_mov_b32 s31, 0x20000
    v_lshrrev_b32 v11, 2, v0
    v_mul_u32_u24 v11, 2688, v11
    v_and_b32 v10, 3, v0
    v_lshl_add_u32 v8, v10, 4, v11
    s_mul_i32 s60, s43, 56
    s_and_b32 s60, s60, -16
    s_lshl_b32 s52, s44, 2
    s_add_u32 s52, s52, s41
    s_lshl_b32 s52, s52, 12
    s_lshl_b32 s53, s45, 3
    s_lshl_b32 s54, s42, 2
    s_add_u32 s53, s53, s54
    v_and_b32 v10, 19, v3
    v_bfe_u32 v11, v3, 2, 1
    v_lshl_add_u32 v10, v11, 3, v10
    v_bfe_u32 v11, v3, 3, 1
    v_lshl_add_u32 v10, v11, 2, v10
    v_lshl_add_u32 v10, v10, 4, s52
    v_mov_b32 v13, 111
    v_add3_u32 v11, s53, v4, 0
    v_mad_u32_u24 v12, v11, 37, v13
    v_lshrrev_b32 v12, 8, v12
    v_add_u32 v11, v11, v12
    v_and_b32 v12, 7, v11
    v_cmp_eq_u32 s[64:65], 3, v12
    v_and_b32 v12, 3, v11
    v_lshrrev_b32 v11, 2, v11
    v_lshl_add_u32 v12, v12, 9, v10
    v_lshl_add_u32 v29, v11, 18, v12
    v_add3_u32 v11, s53, v4, 2
    v_mad_u32_u24 v12, v11, 37, v13
    v_lshrrev_b32 v12, 8, v12
    v_add_u32 v11, v11, v12
    v_and_b32 v12, 7, v11
    v_cmp_eq_u32 s[66:67], 3, v12
    v_and_b32 v12, 3, v11
    v_lshrrev_b32 v11, 2, v11
    v_lshl_add_u32 v12, v12, 9, v10
    v_lshl_add_u32 v30, v11, 18, v12
    v_cndmask_b32 v31, v29, v30, s[66:67]
    v_add_u32 v31, 260608, v31
    s_lshl_b32 s52, s40, 8
    s_add_u32 s52, s52, 155648
    v_lshl_add_u32 v180, v3, 3, s52
    s_lshl_b32 s53, s42, 9
    s_add_u32 s53, s53, 157696
    v_lshl_add_u32 v182, v3, 4, s53
    v_xor_b32 v181, 1024, v180
    v_lshl_add_u32 v183, s41, 2, v182
    s_mov_b32 s68, 0xffff0000
    s_mov_b32 s69, 0xffff0000
    v_mov_b32 v196, v25
    v_mov_b32 v197, 0x3f80
    v_mov_b32 v80, 0
    v_mov_b32 v81, 0
    v_mov_b32 v82, 0
    v_mov_b32 v83, 0
    v_mov_b32 v84, 0
    v_mov_b32 v85, 0
    v_mov_b32 v86, 0
    v_mov_b32 v87, 0
    s_add_u32 m0, s56, 32512
    s_add_u32 s59, s59, 172032
    buffer_load_dwordx4 v5, s[4:7], 0 offen offset:256 lds
    buffer_load_dwordx4 v6, s[4:7], 0 offen offset:1280 lds
    s_add_u32 m0, s57, 16384
    s_nop 0
    buffer_load_dwordx4 v7, s[12:15], s59 offen lds
    s_waitcnt vmcnt(6)
    s_barrier
    ds_read_b128 v[48:51], v16 offset:0
    ds_read_b64_tr_b16 v[64:65], v20 offset:0
    ds_read_b64_tr_b16 v[66:67], v20 offset:512
    ds_read_b128 v[52:55], v17 offset:0
    ds_read_b64_tr_b16 v[68:69], v21 offset:0
    ds_read_b64_tr_b16 v[70:71], v21 offset:512
    s_add_u32 m0, s56, 48768
    s_add_u32 s59, s59, 172032
    buffer_load_dwordx4 v5, s[4:7], 0 offen offset:384 lds
    buffer_load_dwordx4 v6, s[4:7], 0 offen offset:1408 lds
    s_add_u32 m0, s57, 24576
    s_nop 0
    buffer_load_dwordx4 v7, s[12:15], s59 offen lds
    s_waitcnt lgkmcnt(3)
    v_mfma_f32_32x32x16_bf16 v[32:47], v[64:67], v[48:51], 0
    v_mfma_f32_16x16x32_bf16 v[172:175], v[176:179], v[64:67], 0
    v_mfma_f32_16x16x32_bf16 v[164:167], v[176:179], v[48:51], 0
    ds_read_b128 v[56:59], v18 offset:0
    ds_read_b64_tr_b16 v[72:73], v22 offset:0
    ds_read_b64_tr_b16 v[74:75], v22 offset:512
    s_waitcnt lgkmcnt(3)
    v_mfma_f32_32x32x16_bf16 v[32:47], v[68:71], v[52:55], v[32:47]
    v_mfma_f32_16x16x32_bf16 v[164:167], v[176:179], v[52:55], v[164:167]
    ds_read_b128 v[60:63], v19 offset:0
    ds_read_b64_tr_b16 v[76:77], v23 offset:0
    ds_read_b64_tr_b16 v[78:79], v23 offset:512
    v_dot2c_f32_bf16 v168, v48, v48
    v_dot2c_f32_bf16 v169, v49, v49
    v_dot2c_f32_bf16 v170, v50, v50
    v_dot2c_f32_bf16 v171, v51, v51
    v_dot2c_f32_bf16 v168, v52, v52
    v_dot2c_f32_bf16 v169, v53, v53
    v_dot2c_f32_bf16 v170, v54, v54
    v_dot2c_f32_bf16 v171, v55, v55
    s_waitcnt vmcnt(6)
    s_barrier
    s_waitcnt lgkmcnt(3)
    v_mfma_f32_32x32x16_bf16 v[32:47], v[72:75], v[56:59], v[32:47]
    ds_read_b128 v[96:99], v16 offset:16384
    ds_read_b64_tr_b16 v[112:113], v20 offset:8192
    ds_read_b64_tr_b16 v[114:115], v20 offset:8704
    s_waitcnt lgkmcnt(3)
    v_mfma_f32_32x32x16_bf16 v[32:47], v[76:79], v[60:63], v[32:47]
    ds_read_b128 v[100:103], v17 offset:16384
    ds_read_b64_tr_b16 v[116:117], v21 offset:8192
    ds_read_b64_tr_b16 v[118:119], v21 offset:8704
    s_cmp_eq_u32 s80, 7
    s_cbranch_scc0 L_2
    s_lshl_b32 s52, s81, 2
    v_mov_b32 v10, 0
    v_mov_b32 v11, 1
    s_mov_b64 exec, 1
    buffer_store_dword v11, v10, s[28:31], s52 offen offset:128 sc1
    s_mov_b64 exec, -1
L_2:
    s_add_u32 m0, s56, 65024
    s_add_u32 s59, s59, 172032
    buffer_load_dwordx4 v5, s[4:7], 0 offen offset:512 lds
    buffer_load_dwordx4 v6, s[4:7], 0 offen offset:1536 lds
    s_add_u32 m0, s57, 32768
    s_nop 0
    buffer_load_dwordx4 v7, s[12:15], s59 offen lds
    s_waitcnt lgkmcnt(3)
    v_mfma_f32_32x32x16_bf16 v[32:47], v[112:115], v[96:99], v[32:47]
    v_mfma_f32_16x16x32_bf16 v[172:175], v[176:179], v[112:115], v[172:175]
    v_mfma_f32_16x16x32_bf16 v[164:167], v[176:179], v[96:99], v[164:167]
    ds_read_b128 v[104:107], v18 offset:16384
    ds_read_b64_tr_b16 v[120:121], v22 offset:8192
    ds_read_b64_tr_b16 v[122:123], v22 offset:8704
    s_waitcnt lgkmcnt(3)
    v_mfma_f32_32x32x16_bf16 v[32:47], v[116:119], v[100:103], v[32:47]
    v_mfma_f32_16x16x32_bf16 v[164:167], v[176:179], v[100:103], v[164:167]
    ds_read_b128 v[108:111], v19 offset:16384
    ds_read_b64_tr_b16 v[124:125], v23 offset:8192
    ds_read_b64_tr_b16 v[126:127], v23 offset:8704
    v_dot2c_f32_bf16 v168, v96, v96
    v_dot2c_f32_bf16 v169, v97, v97
    v_dot2c_f32_bf16 v170, v98, v98
    v_dot2c_f32_bf16 v171, v99, v99
    v_dot2c_f32_bf16 v168, v100, v100
    v_dot2c_f32_bf16 v169, v101, v101
    v_dot2c_f32_bf16 v170, v102, v102
    v_dot2c_f32_bf16 v171, v103, v103
    s_waitcnt vmcnt(6)
    s_barrier
    s_waitcnt lgkmcnt(3)
    v_mfma_f32_32x32x16_bf16 v[32:47], v[120:123], v[104:107], v[32:47]
    ds_read_b128 v[48:51], v16 offset:32768
    ds_read_b64_tr_b16 v[64:65], v20 offset:16384
    ds_read_b64_tr_b16 v[66:67], v20 offset:16896
    s_waitcnt lgkmcnt(3)
    v_mfma_f32_32x32x16_bf16 v[32:47], v[124:127], v[108:111], v[32:47]
    ds_read_b128 v[52:55], v17 offset:32768
    ds_read_b64_tr_b16 v[68:69], v21 offset:16384
    ds_read_b64_tr_b16 v[70:71], v21 offset:16896
    s_add_u32 m0, s56, 81280
    s_add_u32 s59, s59, 172032
    buffer_load_dwordx4 v5, s[4:7], 0 offen offset:640 lds
    buffer_load_dwordx4 v6, s[4:7], 0 offen offset:1664 lds
    s_add_u32 m0, s57, 40960
    s_nop 0
    buffer_load_dwordx4 v7, s[12:15], s59 offen lds
    s_waitcnt lgkmcnt(3)
    v_mfma_f32_32x32x16_bf16 v[32:47], v[64:67], v[48:51], v[32:47]
    v_mfma_f32_16x16x32_bf16 v[172:175], v[176:179], v[64:67], v[172:175]
    v_mfma_f32_16x16x32_bf16 v[164:167], v[176:179], v[48:51], v[164:167]
    ds_read_b128 v[56:59], v18 offset:32768
    ds_read_b64_tr_b16 v[72:73], v22 offset:16384
    ds_read_b64_tr_b16 v[74:75], v22 offset:16896
    s_waitcnt lgkmcnt(3)
    v_mfma_f32_32x32x16_bf16 v[32:47], v[68:71], v[52:55], v[32:47]
    v_mfma_f32_16x16x32_bf16 v[164:167], v[176:179], v[52:55], v[164:167]
    ds_read_b128 v[60:63], v19 offset:32768
    ds_read_b64_tr_b16 v[76:77], v23 offset:16384
    ds_read_b64_tr_b16 v[78:79], v23 offset:16896
    v_dot2c_f32_bf16 v168, v48, v48
    v_dot2c_f32_bf16 v169, v49, v49
    v_dot2c_f32_bf16 v170, v50, v50
    v_dot2c_f32_bf16 v171, v51, v51
    v_dot2c_f32_bf16 v168, v52, v52
    v_dot2c_f32_bf16 v169, v53, v53
    v_dot2c_f32_bf16 v170, v54, v54
    v_dot2c_f32_bf16 v171, v55, v55
    s_waitcnt vmcnt(6)
    s_barrier
    s_waitcnt lgkmcnt(3)
    v_mfma_f32_32x32x16_bf16 v[32:47], v[72:75], v[56:59], v[32:47]
    ds_read_b128 v[96:99], v16 offset:49152
    ds_read_b64_tr_b16 v[112:113], v20 offset:24576
    ds_read_b64_tr_b16 v[114:115], v20 offset:25088
    s_waitcnt lgkmcnt(3)
    v_mfma_f32_32x32x16_bf16 v[32:47], v[76:79], v[60:63], v[32:47]
    ds_read_b128 v[100:103], v17 offset:49152
    ds_read_b64_tr_b16 v[116:117], v21 offset:24576
    ds_read_b64_tr_b16 v[118:119], v21 offset:25088
    s_add_u32 m0, s56, 97536
    s_add_u32 s59, s59, 172032
    buffer_load_dwordx4 v5, s[4:7], 0 offen offset:768 lds
    buffer_load_dwordx4 v6, s[4:7], 0 offen offset:1792 lds
    s_mov_b32 m0, s57
    s_nop 0
    buffer_load_dwordx4 v7, s[12:15], s59 offen lds
    s_cmp_lt_u32 s45, 7
    s_cbranch_scc1 L_3
    s_lshl_b32 s52, s46, 3
    s_add_u32 s52, s52, s40
    s_lshl_b32 s52, s52, 18
    s_lshl_b32 s53, s44, 14
    s_add_u32 s52, s52, s53
    v_lshrrev_b32 v10, 4, v1
    v_lshlrev_b32 v10, 12, v10
    v_bfe_u32 v12, v0, 2, 2
    v_lshl_add_u32 v10, v12, 9, v10
    v_and_b32 v15, 3, v0
    v_lshl_add_u32 v10, v15, 4, v10
    v_cmp_eq_u32 vcc, 0, v15
    s_nop 1
    v_cndmask_b32 v12, 0, v25, vcc
    v_mov_b32 v13, v12
    v_mov_b32 v14, v12
    v_mov_b32 v15, v12
    buffer_store_dwordx4 v[12:15], v10, s[20:23], s52 offen offset:2496 sc1
L_3:
    s_getpc_b64 s[2:3]
L_pc1:
    s_and_b32 s52, s81, 0xf8
    s_add_u32 s52, s52, s40
    s_lshl_b32 s52, s52, 8
    v_lshl_add_u32 v10, v4, 7, s52
    v_min_u32 v10, L_end-L_pc1, v10
    global_load_dword v9, v10, s[2:3]
    s_waitcnt lgkmcnt(3)
    v_mfma_f32_32x32x16_bf16 v[32:47], v[112:115], v[96:99], v[32:47]
    v_mfma_f32_16x16x32_bf16 v[172:175], v[176:179], v[112:115], v[172:175]
    v_mfma_f32_16x16x32_bf16 v[164:167], v[176:179], v[96:99], v[164:167]
    ds_read_b128 v[104:107], v18 offset:49152
    ds_read_b64_tr_b16 v[120:121], v22 offset:24576
    ds_read_b64_tr_b16 v[122:123], v22 offset:25088
    s_waitcnt lgkmcnt(3)
    v_mfma_f32_32x32x16_bf16 v[32:47], v[116:119], v[100:103], v[32:47]
    v_mfma_f32_16x16x32_bf16 v[164:167], v[176:179], v[100:103], v[164:167]
    ds_read_b128 v[108:111], v19 offset:49152
    ds_read_b64_tr_b16 v[124:125], v23 offset:24576
    ds_read_b64_tr_b16 v[126:127], v23 offset:25088
    v_dot2c_f32_bf16 v168, v96, v96
    v_dot2c_f32_bf16 v169, v97, v97
    v_dot2c_f32_bf16 v170, v98, v98
    v_dot2c_f32_bf16 v171, v99, v99
    v_dot2c_f32_bf16 v168, v100, v100
    v_dot2c_f32_bf16 v169, v101, v101
    v_dot2c_f32_bf16 v170, v102, v102
    v_dot2c_f32_bf16 v171, v103, v103
    s_waitcnt vmcnt(7)
    s_barrier
    s_waitcnt lgkmcnt(3)
    v_mfma_f32_32x32x16_bf16 v[32:47], v[120:123], v[104:107], v[32:47]
    v_add_u32 v16, 0x10000, v16
    ds_read_b128 v[48:51], v16 offset:0
    ds_read_b64_tr_b16 v[64:65], v20 offset:32768
    ds_read_b64_tr_b16 v[66:67], v20 offset:33280
    s_waitcnt lgkmcnt(3)
    v_mfma_f32_32x32x16_bf16 v[32:47], v[124:127], v[108:111], v[32:47]
    v_add_u32 v17, 0x10000, v17
    ds_read_b128 v[52:55], v17 offset:0
    ds_read_b64_tr_b16 v[68:69], v21 offset:32768
    ds_read_b64_tr_b16 v[70:71], v21 offset:33280
    s_add_u32 m0, s57, 8192
    s_nop 0
    buffer_load_dwordx4 v8, s[8:11], s60 offen lds
    s_add_u32 m0, s57, 16384
    s_add_u32 s60, s60, 344064
    buffer_load_dwordx4 v8, s[8:11], s60 offen lds
    s_waitcnt lgkmcnt(3)
    v_mfma_f32_32x32x16_bf16 v[32:47], v[64:67], v[48:51], v[32:47]
    v_mfma_f32_16x16x32_bf16 v[172:175], v[176:179], v[64:67], v[172:175]
    v_mfma_f32_16x16x32_bf16 v[164:167], v[176:179], v[48:51], v[164:167]
    v_add_u32 v18, 0x10000, v18
    ds_read_b128 v[56:59], v18 offset:0
    ds_read_b64_tr_b16 v[72:73], v22 offset:32768
    ds_read_b64_tr_b16 v[74:75], v22 offset:33280
    s_waitcnt lgkmcnt(3)
    v_mfma_f32_32x32x16_bf16 v[32:47], v[68:71], v[52:55], v[32:47]
    v_mfma_f32_16x16x32_bf16 v[164:167], v[176:179], v[52:55], v[164:167]
    v_add_u32 v19, 0x10000, v19
    ds_read_b128 v[60:63], v19 offset:0
    ds_read_b64_tr_b16 v[76:77], v23 offset:32768
    ds_read_b64_tr_b16 v[78:79], v23 offset:33280
    v_dot2c_f32_bf16 v168, v48, v48
    v_dot2c_f32_bf16 v169, v49, v49
    v_dot2c_f32_bf16 v170, v50, v50
    v_dot2c_f32_bf16 v171, v51, v51
    v_dot2c_f32_bf16 v168, v52, v52
    v_dot2c_f32_bf16 v169, v53, v53
    v_dot2c_f32_bf16 v170, v54, v54
    v_dot2c_f32_bf16 v171, v55, v55
    s_waitcnt vmcnt(6)
    s_barrier
    s_waitcnt lgkmcnt(3)
    v_mfma_f32_32x32x16_bf16 v[32:47], v[72:75], v[56:59], v[32:47]
    ds_read_b128 v[96:99], v16 offset:16384
    ds_read_b64_tr_b16 v[112:113], v20 offset:40960
    ds_read_b64_tr_b16 v[114:115], v20 offset:41472
    s_waitcnt lgkmcnt(3)
    v_mfma_f32_32x32x16_bf16 v[32:47], v[76:79], v[60:63], v[32:47]
    ds_read_b128 v[100:103], v17 offset:16384
    ds_read_b64_tr_b16 v[116:117], v21 offset:40960
    ds_read_b64_tr_b16 v[118:119], v21 offset:41472
    s_add_u32 m0, s57, 24576
    s_add_u32 s60, s60, 344064
    buffer_load_dwordx4 v8, s[8:11], s60 offen lds
    v_lshlrev_b32 v10, 2, v1
    buffer_load_dword v160, v10, s[28:31], 0 offen offset:128 sc1
    s_waitcnt lgkmcnt(3)
    v_mfma_f32_32x32x16_bf16 v[32:47], v[112:115], v[96:99], v[32:47]
    v_mfma_f32_16x16x32_bf16 v[172:175], v[176:179], v[112:115], v[172:175]
    v_mfma_f32_16x16x32_bf16 v[164:167], v[176:179], v[96:99], v[164:167]
    ds_read_b128 v[104:107], v18 offset:16384
    ds_read_b64_tr_b16 v[120:121], v22 offset:40960
    ds_read_b64_tr_b16 v[122:123], v22 offset:41472
    s_waitcnt lgkmcnt(3)
    v_mfma_f32_32x32x16_bf16 v[32:47], v[116:119], v[100:103], v[32:47]
    v_mfma_f32_16x16x32_bf16 v[164:167], v[176:179], v[100:103], v[164:167]
    ds_read_b128 v[108:111], v19 offset:16384
    ds_read_b64_tr_b16 v[124:125], v23 offset:40960
    ds_read_b64_tr_b16 v[126:127], v23 offset:41472
    v_dot2c_f32_bf16 v168, v96, v96
    v_dot2c_f32_bf16 v169, v97, v97
    v_dot2c_f32_bf16 v170, v98, v98
    v_dot2c_f32_bf16 v171, v99, v99
    v_dot2c_f32_bf16 v168, v100, v100
    v_dot2c_f32_bf16 v169, v101, v101
    v_dot2c_f32_bf16 v170, v102, v102
    v_dot2c_f32_bf16 v171, v103, v103
    s_waitcnt vmcnt(5) lgkmcnt(0)
    s_barrier
    ds_read_b128 v[48:51], v16 offset:32768
    ds_read_b64_tr_b16 v[64:65], v20 offset:0
    ds_read_b64_tr_b16 v[66:67], v20 offset:512
    ds_read_b128 v[52:55], v17 offset:32768
    ds_read_b64_tr_b16 v[68:69], v21 offset:0
    ds_read_b64_tr_b16 v[70:71], v21 offset:512
    v_mfma_f32_32x32x16_bf16 v[32:47], v[120:123], v[104:107], v[32:47]
    ds_read_b128 v[56:59], v18 offset:32768
    ds_read_b64_tr_b16 v[72:73], v22 offset:0
    ds_read_b64_tr_b16 v[74:75], v22 offset:512
    v_mfma_f32_32x32x16_bf16 v[32:47], v[124:127], v[108:111], v[32:47]
    ds_read_b128 v[60:63], v19 offset:32768
    ds_read_b64_tr_b16 v[76:77], v23 offset:0
    ds_read_b64_tr_b16 v[78:79], v23 offset:512
    s_add_u32 m0, s57, 32768
    s_add_u32 s60, s60, 344064
    buffer_load_dwordx4 v8, s[8:11], s60 offen lds
    s_waitcnt lgkmcnt(6)
    v_mfma_f32_16x16x32_bf16 v[164:167], v[176:179], v[48:51], v[164:167]
    v_mfma_f32_16x16x32_bf16 v[172:175], v[176:179], v[64:67], v[172:175]
    v_mfma_f32_16x16x32_bf16 v[164:167], v[176:179], v[52:55], v[164:167]
    v_dot2c_f32_bf16 v168, v48, v48
    v_dot2c_f32_bf16 v169, v49, v49
    v_dot2c_f32_bf16 v170, v50, v50
    v_dot2c_f32_bf16 v171, v51, v51
    v_dot2c_f32_bf16 v168, v52, v52
    v_dot2c_f32_bf16 v169, v53, v53
    v_dot2c_f32_bf16 v170, v54, v54
    v_dot2c_f32_bf16 v171, v55, v55
    v_mfma_f32_32x32x16_bf16 v[32:47], v[64:67], v[48:51], v[32:47]
    v_cndmask_b32 v172, v172, v173, s[68:69]
    v_add_f32 v168, v168, v169
    v_add_f32 v170, v170, v171
    ds_write_b32 v183, v172
    v_add_f32 v168, v168, v170
    v_cndmask_b32 v164, v164, v165, s[68:69]
    v_mov_b32 v12, v168
    v_mfma_f32_32x32x16_bf16 v[32:47], v[68:71], v[52:55], v[32:47]
    s_nop 0
    v_permlane32_swap_b32 v168, v12
    v_add_f32 v165, v168, v12
    ds_write_b64 v180, v[164:165]
    s_waitcnt vmcnt(2) lgkmcnt(0)
    s_barrier
    ds_read_b64 v[90:91], v181
    ds_read_b128 v[96:99], v182
    v_mfma_f32_32x32x16_bf16 v[32:47], v[72:75], v[56:59], v[32:47]
    v_mfma_f32_32x32x16_bf16 v[32:47], v[76:79], v[60:63], v[32:47]
    s_waitcnt lgkmcnt(1)
    v_add_f32 v90, v90, v164
    v_add_f32 v91, v91, v165
    v_mul_f32 v90, 0x3b124925, v90
    s_waitcnt lgkmcnt(0)
    v_add_f32 v96, v96, v97
    v_add_f32 v98, v98, v99
    v_mul_f32 v91, 0x3b124925, v91
    v_add_f32 v96, v96, v98
    s_mov_b32 exec_hi, 0
    v_cvt_pk_bf16_f32 v80, -v90, -v90
    s_mov_b32 exec_hi, -1
    v_and_b32 v97, 0xffff0000, v96
    v_fma_f32 v91, -v90, v90, v91
    v_sub_f32 v98, v96, v97
    v_cvt_pk_bf16_f32 v84, v97, v98
    v_max_f32 v91, 0, v91
    v_cvt_pk_bf16_f32 v91, v91, v91
    v_mfma_f32_32x32x16_bf16 v[32:47], v[84:87], v[80:83], v[32:47]
    v_and_b32 v91, 0xffff0000, v91
    v_add_f32 v91, 0x3727c5ac, v91
    v_cvt_pk_bf16_f32 v91, v91, v91
    v_and_b32 v91, 0xffff0000, v91
    v_sqrt_f32 v91, v91
    s_cmp_eq_u32 s45, 7
    v_cvt_pk_bf16_f32 v91, v91, v91
    v_and_b32 v91, 0xffff0000, v91
    v_rcp_f32 v88, v91
    s_cbranch_scc1 L_padwg
    s_nop 1
    v_pk_mul_f32 v[32:33], v[32:33], v[88:89] op_sel_hi:[1,0]
    v_pk_mul_f32 v[34:35], v[34:35], v[88:89] op_sel_hi:[1,0]
    v_pk_mul_f32 v[36:37], v[36:37], v[88:89] op_sel_hi:[1,0]
    v_pk_mul_f32 v[38:39], v[38:39], v[88:89] op_sel_hi:[1,0]
    v_pk_mul_f32 v[40:41], v[40:41], v[88:89] op_sel_hi:[1,0]
    v_pk_mul_f32 v[42:43], v[42:43], v[88:89] op_sel_hi:[1,0]
    v_pk_mul_f32 v[44:45], v[44:45], v[88:89] op_sel_hi:[1,0]
    v_pk_mul_f32 v[46:47], v[46:47], v[88:89] op_sel_hi:[1,0]
    v_cvt_pk_bf16_f32 v48, v32, v33
    v_cvt_pk_bf16_f32 v49, v34, v35
    v_cvt_pk_bf16_f32 v50, v36, v37
    v_cvt_pk_bf16_f32 v51, v38, v39
    v_cvt_pk_bf16_f32 v52, v40, v41
    v_cvt_pk_bf16_f32 v53, v42, v43
    v_cvt_pk_bf16_f32 v54, v44, v45
    v_cvt_pk_bf16_f32 v55, v46, v47
    v_permlane32_swap_b32 v48, v50
    v_permlane32_swap_b32 v49, v51
    v_permlane32_swap_b32 v52, v54
    v_permlane32_swap_b32 v53, v55
    v_cndmask_b32 v198, v50, v54, s[66:67]
    v_cndmask_b32 v199, v51, v55, s[66:67]
    v_cndmask_b32 v50, v50, v196, s[64:65]
    v_cndmask_b32 v51, v51, v197, s[64:65]
    v_cndmask_b32 v54, v54, v196, s[66:67]
    v_cndmask_b32 v55, v55, v197, s[66:67]
    buffer_store_dwordx4 v[48:51], v29, s[20:23], 0 offen sc1
    buffer_store_dwordx4 v[52:55], v30, s[20:23], 0 offen sc1
    s_or_b64 exec, s[64:65], s[66:67]
    s_cbranch_execz L_4
    buffer_store_dwordx4 v[196:199], v31, s[20:23], 0 offen sc1
L_4:
    s_mov_b64 exec, -1
    s_branch L_qpass
L_padwg:
    s_waitcnt vmcnt(0)
    s_branch L_qpass
    .fill 100, 4, 0xbf810000
L_vpass:
    s_mov_b32 s8, s12
    s_mov_b32 s9, s13
    s_mov_b32 s10, 1204224
    s_mov_b32 s11, 0x20000
    s_mov_b32 s30, 256
    s_mov_b32 s31, 0x20000
    v_lshrrev_b32 v11, 2, v0
    v_mul_u32_u24 v11, 2688, v11
    v_and_b32 v10, 3, v0
    v_lshl_add_u32 v8, v10, 4, v11
    s_mul_i32 s60, s43, 56
    s_and_b32 s60, s60, -16
    s_lshl_b32 s52, s44, 2
    s_add_u32 s52, s52, s41
    s_lshl_b32 s52, s52, 12
    s_lshl_b32 s53, s45, 6
    s_lshl_b32 s54, s42, 5
    s_add_u32 s53, s53, s54
    v_add_u32 v10, s53, v3
    v_mul_u32_u24 v11, 2341, v10
    v_lshrrev_b32 v11, 16, v11
    v_mul_u32_u24 v12, 28, v11
    v_sub_u32 v12, v10, v12
    v_lshlrev_b32 v11, 18, v11
    v_lshl_add_u32 v11, v12, 4, v11
    v_lshl_add_u32 v11, v4, 9, v11
    v_add_u32 v29, s52, v11
    s_lshl_b32 s52, s40, 8
    s_add_u32 s52, s52, 155648
    v_lshl_add_u32 v180, v3, 3, s52
    s_lshl_b32 s53, s42, 9
    s_add_u32 s53, s53, 157696
    v_lshl_add_u32 v182, v3, 4, s53
    v_xor_b32 v181, 1024, v180
    v_lshl_add_u32 v183, s41, 2, v182
    s_mov_b32 s68, 0xffff0000
    s_mov_b32 s69, 0xffff0000
    s_lshl_b32 s52, s40, 7
    s_add_u32 s52, s52, 158720
    v_lshl_add_u32 v30, v3, 2, s52
    v_lshl_add_u32 v31, v4, 4, s52
    v_mov_b32 v80, 0
    v_mov_b32 v81, 0
    v_mov_b32 v82, 0
    v_mov_b32 v83, 0
    v_mov_b32 v84, 0
    v_mov_b32 v85, 0
    v_mov_b32 v86, 0
    v_mov_b32 v87, 0
    s_add_u32 m0, s56, 32512
    s_add_u32 s59, s59, 172032
    buffer_load_dwordx4 v5, s[4:7], 0 offen offset:256 lds
    buffer_load_dwordx4 v6, s[4:7], 0 offen offset:1280 lds
    s_add_u32 m0, s57, 16384
    s_nop 0
    buffer_load_dwordx4 v7, s[12:15], s59 offen lds
    s_waitcnt vmcnt(6)
    s_barrier
    ds_read_b128 v[48:51], v16 offset:0
    ds_read_b64_tr_b16 v[64:65], v20 offset:0
    ds_read_b64_tr_b16 v[66:67], v20 offset:512
    ds_read_b128 v[52:55], v17 offset:0
    ds_read_b64_tr_b16 v[68:69], v21 offset:0
    ds_read_b64_tr_b16 v[70:71], v21 offset:512
    s_add_u32 m0, s56, 48768
    s_add_u32 s59, s59, 172032
    buffer_load_dwordx4 v5, s[4:7], 0 offen offset:384 lds
    buffer_load_dwordx4 v6, s[4:7], 0 offen offset:1408 lds
    s_add_u32 m0, s57, 24576
    s_nop 0
    buffer_load_dwordx4 v7, s[12:15], s59 offen lds
    s_waitcnt lgkmcnt(3)
    v_mfma_f32_32x32x16_bf16 v[32:47], v[48:51], v[64:67], 0
    v_mfma_f32_16x16x32_bf16 v[172:175], v[176:179], v[64:67], 0
    v_mfma_f32_16x16x32_bf16 v[164:167], v[176:179], v[48:51], 0
    ds_read_b128 v[56:59], v18 offset:0
    ds_read_b64_tr_b16 v[72:73], v22 offset:0
    ds_read_b64_tr_b16 v[74:75], v22 offset:512
    s_waitcnt lgkmcnt(3)
    v_mfma_f32_32x32x16_bf16 v[32:47], v[52:55], v[68:71], v[32:47]
    v_mfma_f32_16x16x32_bf16 v[164:167], v[176:179], v[52:55], v[164:167]
    ds_read_b128 v[60:63], v19 offset:0
    ds_read_b64_tr_b16 v[76:77], v23 offset:0
    ds_read_b64_tr_b16 v[78:79], v23 offset:512
    v_dot2c_f32_bf16 v168, v48, v48
    v_dot2c_f32_bf16 v169, v49, v49
    v_dot2c_f32_bf16 v170, v50, v50
    v_dot2c_f32_bf16 v171, v51, v51
    v_dot2c_f32_bf16 v168, v52, v52
    v_dot2c_f32_bf16 v169, v53, v53
    v_dot2c_f32_bf16 v170, v54, v54
    v_dot2c_f32_bf16 v171, v55, v55
    s_waitcnt vmcnt(6)
    s_barrier
    s_waitcnt lgkmcnt(3)
    v_mfma_f32_32x32x16_bf16 v[32:47], v[56:59], v[72:75], v[32:47]
    ds_read_b128 v[96:99], v16 offset:16384
    ds_read_b64_tr_b16 v[112:113], v20 offset:8192
    ds_read_b64_tr_b16 v[114:115], v20 offset:8704
    s_waitcnt lgkmcnt(3)
    v_mfma_f32_32x32x16_bf16 v[32:47], v[60:63], v[76:79], v[32:47]
    ds_read_b128 v[100:103], v17 offset:16384
    ds_read_b64_tr_b16 v[116:117], v21 offset:8192
    ds_read_b64_tr_b16 v[118:119], v21 offset:8704
    s_cmp_eq_u32 s80, 7
    s_cbranch_scc0 L_5
    s_lshl_b32 s52, s81, 2
    v_mov_b32 v10, 0
    v_mov_b32 v11, 1
    s_mov_b64 exec, 1
    buffer_store_dword v11, v10, s[28:31], s52 offen offset:128 sc1
    s_mov_b64 exec, -1
L_5:
    s_add_u32 m0, s56, 65024
    s_add_u32 s59, s59, 172032
    buffer_load_dwordx4 v5, s[4:7], 0 offen offset:512 lds
    buffer_load_dwordx4 v6, s[4:7], 0 offen offset:1536 lds
    s_add_u32 m0, s57, 32768
    s_nop 0
    buffer_load_dwordx4 v7, s[12:15], s59 offen lds
    s_waitcnt lgkmcnt(3)
    v_mfma_f32_32x32x16_bf16 v[32:47], v[96:99], v[112:115], v[32:47]
    v_mfma_f32_16x16x32_bf16 v[172:175], v[176:179], v[112:115], v[172:175]
    v_mfma_f32_16x16x32_bf16 v[164:167], v[176:179], v[96:99], v[164:167]
    ds_read_b128 v[104:107], v18 offset:16384
    ds_read_b64_tr_b16 v[120:121], v22 offset:8192
    ds_read_b64_tr_b16 v[122:123], v22 offset:8704
    s_waitcnt lgkmcnt(3)
    v_mfma_f32_32x32x16_bf16 v[32:47], v[100:103], v[116:119], v[32:47]
    v_mfma_f32_16x16x32_bf16 v[164:167], v[176:179], v[100:103], v[164:167]
    ds_read_b128 v[108:111], v19 offset:16384
    ds_read_b64_tr_b16 v[124:125], v23 offset:8192
    ds_read_b64_tr_b16 v[126:127], v23 offset:8704
    v_dot2c_f32_bf16 v168, v96, v96
    v_dot2c_f32_bf16 v169, v97, v97
    v_dot2c_f32_bf16 v170, v98, v98
    v_dot2c_f32_bf16 v171, v99, v99
    v_dot2c_f32_bf16 v168, v100, v100
    v_dot2c_f32_bf16 v169, v101, v101
    v_dot2c_f32_bf16 v170, v102, v102
    v_dot2c_f32_bf16 v171, v103, v103
    s_waitcnt vmcnt(6)
    s_barrier
    s_waitcnt lgkmcnt(3)
    v_mfma_f32_32x32x16_bf16 v[32:47], v[104:107], v[120:123], v[32:47]
    ds_read_b128 v[48:51], v16 offset:32768
    ds_read_b64_tr_b16 v[64:65], v20 offset:16384
    ds_read_b64_tr_b16 v[66:67], v20 offset:16896
    s_waitcnt lgkmcnt(3)
    v_mfma_f32_32x32x16_bf16 v[32:47], v[108:111], v[124:127], v[32:47]
    ds_read_b128 v[52:55], v17 offset:32768
    ds_read_b64_tr_b16 v[68:69], v21 offset:16384
    ds_read_b64_tr_b16 v[70:71], v21 offset:16896
    s_add_u32 m0, s56, 81280
    s_add_u32 s59, s59, 172032
    buffer_load_dwordx4 v5, s[4:7], 0 offen offset:640 lds
    buffer_load_dwordx4 v6, s[4:7], 0 offen offset:1664 lds
    s_add_u32 m0, s57, 40960
    s_nop 0
    buffer_load_dwordx4 v7, s[12:15], s59 offen lds
    s_waitcnt lgkmcnt(3)
    v_mfma_f32_32x32x16_bf16 v[32:47], v[48:51], v[64:67], v[32:47]
    v_mfma_f32_16x16x32_bf16 v[172:175], v[176:179], v[64:67], v[172:175]
    v_mfma_f32_16x16x32_bf16 v[164:167], v[176:179], v[48:51], v[164:167]
    ds_read_b128 v[56:59], v18 offset:32768
    ds_read_b64_tr_b16 v[72:73], v22 offset:16384
    ds_read_b64_tr_b16 v[74:75], v22 offset:16896
    s_waitcnt lgkmcnt(3)
    v_mfma_f32_32x32x16_bf16 v[32:47], v[52:55], v[68:71], v[32:47]
    v_mfma_f32_16x16x32_bf16 v[164:167], v[176:179], v[52:55], v[164:167]
    ds_read_b128 v[60:63], v19 offset:32768
    ds_read_b64_tr_b16 v[76:77], v23 offset:16384
    ds_read_b64_tr_b16 v[78:79], v23 offset:16896
    v_dot2c_f32_bf16 v168, v48, v48
    v_dot2c_f32_bf16 v169, v49, v49
    v_dot2c_f32_bf16 v170, v50, v50
    v_dot2c_f32_bf16 v171, v51, v51
    v_dot2c_f32_bf16 v168, v52, v52
    v_dot2c_f32_bf16 v169, v53, v53
    v_dot2c_f32_bf16 v170, v54, v54
    v_dot2c_f32_bf16 v171, v55, v55
    s_waitcnt vmcnt(6)
    s_barrier
    s_waitcnt lgkmcnt(3)
    v_mfma_f32_32x32x16_bf16 v[32:47], v[56:59], v[72:75], v[32:47]
    ds_read_b128 v[96:99], v16 offset:49152
    ds_read_b64_tr_b16 v[112:113], v20 offset:24576
    ds_read_b64_tr_b16 v[114:115], v20 offset:25088
    s_waitcnt lgkmcnt(3)
    v_mfma_f32_32x32x16_bf16 v[32:47], v[60:63], v[76:79], v[32:47]
    ds_read_b128 v[100:103], v17 offset:49152
    ds_read_b64_tr_b16 v[116:117], v21 offset:24576
    ds_read_b64_tr_b16 v[118:119], v21 offset:25088
    s_add_u32 m0, s56, 97536
    s_add_u32 s59, s59, 172032
    buffer_load_dwordx4 v5, s[4:7], 0 offen offset:768 lds
    buffer_load_dwordx4 v6, s[4:7], 0 offen offset:1792 lds
    s_mov_b32 m0, s57
    s_nop 0
    buffer_load_dwordx4 v7, s[12:15], s59 offen lds
    s_cmp_lt_u32 s45, 7
    s_cbranch_scc1 L_6
    s_lshl_b32 s52, s46, 3
    s_add_u32 s52, s52, s40
    s_lshl_b32 s52, s52, 18
    s_lshl_b32 s53, s44, 14
    s_add_u32 s52, s52, s53
    v_lshrrev_b32 v10, 4, v1
    v_lshlrev_b32 v10, 12, v10
    v_bfe_u32 v12, v0, 2, 2
    v_lshl_add_u32 v10, v12, 9, v10
    v_and_b32 v15, 3, v0
    v_lshl_add_u32 v10, v15, 4, v10
    v_cmp_eq_u32 vcc, 0, v15
    s_nop 1
    v_cndmask_b32 v12, 0, v25, vcc
    v_mov_b32 v13, v12
    v_mov_b32 v14, v12
    v_mov_b32 v15, v12
    buffer_store_dwordx4 v[12:15], v10, s[20:23], s52 offen offset:2496 sc1
L_6:
    s_getpc_b64 s[2:3]
L_pc2:
    s_and_b32 s52, s81, 0xf8
    s_add_u32 s52, s52, s40
    s_lshl_b32 s52, s52, 8
    v_lshl_add_u32 v10, v4, 7, s52
    v_min_u32 v10, L_end-L_pc2, v10
    global_load_dword v9, v10, s[2:3]
    s_waitcnt lgkmcnt(3)
    v_mfma_f32_32x32x16_bf16 v[32:47], v[96:99], v[112:115], v[32:47]
    v_mfma_f32_16x16x32_bf16 v[172:175], v[176:179], v[112:115], v[172:175]
    v_mfma_f32_16x16x32_bf16 v[164:167], v[176:179], v[96:99], v[164:167]
    ds_read_b128 v[104:107], v18 offset:49152
    ds_read_b64_tr_b16 v[120:121], v22 offset:24576
    ds_read_b64_tr_b16 v[122:123], v22 offset:25088
    s_waitcnt lgkmcnt(3)
    v_mfma_f32_32x32x16_bf16 v[32:47], v[100:103], v[116:119], v[32:47]
    v_mfma_f32_16x16x32_bf16 v[164:167], v[176:179], v[100:103], v[164:167]
    ds_read_b128 v[108:111], v19 offset:49152
    ds_read_b64_tr_b16 v[124:125], v23 offset:24576
    ds_read_b64_tr_b16 v[126:127], v23 offset:25088
    v_dot2c_f32_bf16 v168, v96, v96
    v_dot2c_f32_bf16 v169, v97, v97
    v_dot2c_f32_bf16 v170, v98, v98
    v_dot2c_f32_bf16 v171, v99, v99
    v_dot2c_f32_bf16 v168, v100, v100
    v_dot2c_f32_bf16 v169, v101, v101
    v_dot2c_f32_bf16 v170, v102, v102
    v_dot2c_f32_bf16 v171, v103, v103
    s_waitcnt vmcnt(7)
    s_barrier
    s_waitcnt lgkmcnt(3)
    v_mfma_f32_32x32x16_bf16 v[32:47], v[104:107], v[120:123], v[32:47]
    v_add_u32 v16, 0x10000, v16
    ds_read_b128 v[48:51], v16 offset:0
    ds_read_b64_tr_b16 v[64:65], v20 offset:32768
    ds_read_b64_tr_b16 v[66:67], v20 offset:33280
    s_waitcnt lgkmcnt(3)
    v_mfma_f32_32x32x16_bf16 v[32:47], v[108:111], v[124:127], v[32:47]
    v_add_u32 v17, 0x10000, v17
    ds_read_b128 v[52:55], v17 offset:0
    ds_read_b64_tr_b16 v[68:69], v21 offset:32768
    ds_read_b64_tr_b16 v[70:71], v21 offset:33280
    s_add_u32 m0, s57, 8192
    s_nop 0
    buffer_load_dwordx4 v8, s[8:11], s60 offen lds
    s_add_u32 m0, s57, 16384
    s_add_u32 s60, s60, 344064
    buffer_load_dwordx4 v8, s[8:11], s60 offen lds
    s_waitcnt lgkmcnt(3)
    v_mfma_f32_32x32x16_bf16 v[32:47], v[48:51], v[64:67], v[32:47]
    v_mfma_f32_16x16x32_bf16 v[172:175], v[176:179], v[64:67], v[172:175]
    v_mfma_f32_16x16x32_bf16 v[164:167], v[176:179], v[48:51], v[164:167]
    v_add_u32 v18, 0x10000, v18
    ds_read_b128 v[56:59], v18 offset:0
    ds_read_b64_tr_b16 v[72:73], v22 offset:32768
    ds_read_b64_tr_b16 v[74:75], v22 offset:33280
    s_waitcnt lgkmcnt(3)
    v_mfma_f32_32x32x16_bf16 v[32:47], v[52:55], v[68:71], v[32:47]
    v_mfma_f32_16x16x32_bf16 v[164:167], v[176:179], v[52:55], v[164:167]
    v_add_u32 v19, 0x10000, v19
    ds_read_b128 v[60:63], v19 offset:0
    ds_read_b64_tr_b16 v[76:77], v23 offset:32768
    ds_read_b64_tr_b16 v[78:79], v23 offset:33280
    v_dot2c_f32_bf16 v168, v48, v48
    v_dot2c_f32_bf16 v169, v49, v49
    v_dot2c_f32_bf16 v170, v50, v50
    v_dot2c_f32_bf16 v171, v51, v51
    v_dot2c_f32_bf16 v168, v52, v52
    v_dot2c_f32_bf16 v169, v53, v53
    v_dot2c_f32_bf16 v170, v54, v54
    v_dot2c_f32_bf16 v171, v55, v55
    s_waitcnt vmcnt(6)
    s_barrier
    s_waitcnt lgkmcnt(3)
    v_mfma_f32_32x32x16_bf16 v[32:47], v[56:59], v[72:75], v[32:47]
    ds_read_b128 v[96:99], v16 offset:16384
    ds_read_b64_tr_b16 v[112:113], v20 offset:40960
    ds_read_b64_tr_b16 v[114:115], v20 offset:41472
    s_waitcnt lgkmcnt(3)
    v_mfma_f32_32x32x16_bf16 v[32:47], v[60:63], v[76:79], v[32:47]
    ds_read_b128 v[100:103], v17 offset:16384
    ds_read_b64_tr_b16 v[116:117], v21 offset:40960
    ds_read_b64_tr_b16 v[118:119], v21 offset:41472
    s_add_u32 m0, s57, 24576
    s_add_u32 s60, s60, 344064
    buffer_load_dwordx4 v8, s[8:11], s60 offen lds
    v_lshlrev_b32 v10, 2, v1
    buffer_load_dword v160, v10, s[28:31], 0 offen offset:128 sc1
    s_waitcnt lgkmcnt(3)
    v_mfma_f32_32x32x16_bf16 v[32:47], v[96:99], v[112:115], v[32:47]
    v_mfma_f32_16x16x32_bf16 v[172:175], v[176:179], v[112:115], v[172:175]
    v_mfma_f32_16x16x32_bf16 v[164:167], v[176:179], v[96:99], v[164:167]
    ds_read_b128 v[104:107], v18 offset:16384
    ds_read_b64_tr_b16 v[120:121], v22 offset:40960
    ds_read_b64_tr_b16 v[122:123], v22 offset:41472
    s_waitcnt lgkmcnt(3)
    v_mfma_f32_32x32x16_bf16 v[32:47], v[100:103], v[116:119], v[32:47]
    v_mfma_f32_16x16x32_bf16 v[164:167], v[176:179], v[100:103], v[164:167]
    ds_read_b128 v[108:111], v19 offset:16384
    ds_read_b64_tr_b16 v[124:125], v23 offset:40960
    ds_read_b64_tr_b16 v[126:127], v23 offset:41472
    v_dot2c_f32_bf16 v168, v96, v96
    v_dot2c_f32_bf16 v169, v97, v97
    v_dot2c_f32_bf16 v170, v98, v98
    v_dot2c_f32_bf16 v171, v99, v99
    v_dot2c_f32_bf16 v168, v100, v100
    v_dot2c_f32_bf16 v169, v101, v101
    v_dot2c_f32_bf16 v170, v102, v102
    v_dot2c_f32_bf16 v171, v103, v103
    s_waitcnt vmcnt(5) lgkmcnt(0)
    s_barrier
    ds_read_b128 v[48:51], v16 offset:32768
    ds_read_b64_tr_b16 v[64:65], v20 offset:0
    ds_read_b64_tr_b16 v[66:67], v20 offset:512
    ds_read_b128 v[52:55], v17 offset:32768
    ds_read_b64_tr_b16 v[68:69], v21 offset:0
    ds_read_b64_tr_b16 v[70:71], v21 offset:512
    v_mfma_f32_32x32x16_bf16 v[32:47], v[104:107], v[120:123], v[32:47]
    ds_read_b128 v[56:59], v18 offset:32768
    ds_read_b64_tr_b16 v[72:73], v22 offset:0
    ds_read_b64_tr_b16 v[74:75], v22 offset:512
    v_mfma_f32_32x32x16_bf16 v[32:47], v[108:111], v[124:127], v[32:47]
    ds_read_b128 v[60:63], v19 offset:32768
    ds_read_b64_tr_b16 v[76:77], v23 offset:0
    ds_read_b64_tr_b16 v[78:79], v23 offset:512
    s_add_u32 m0, s57, 32768
    s_add_u32 s60, s60, 344064
    buffer_load_dwordx4 v8, s[8:11], s60 offen lds
    s_waitcnt lgkmcnt(6)
    v_mfma_f32_16x16x32_bf16 v[164:167], v[176:179], v[48:51], v[164:167]
    v_mfma_f32_16x16x32_bf16 v[172:175], v[176:179], v[64:67], v[172:175]
    v_mfma_f32_16x16x32_bf16 v[164:167], v[176:179], v[52:55], v[164:167]
    v_dot2c_f32_bf16 v168, v48, v48
    v_dot2c_f32_bf16 v169, v49, v49
    v_dot2c_f32_bf16 v170, v50, v50
    v_dot2c_f32_bf16 v171, v51, v51
    v_dot2c_f32_bf16 v168, v52, v52
    v_dot2c_f32_bf16 v169, v53, v53
    v_dot2c_f32_bf16 v170, v54, v54
    v_dot2c_f32_bf16 v171, v55, v55
    v_mfma_f32_32x32x16_bf16 v[32:47], v[48:51], v[64:67], v[32:47]
    v_cndmask_b32 v172, v172, v173, s[68:69]
    v_add_f32 v168, v168, v169
    v_add_f32 v170, v170, v171
    ds_write_b32 v183, v172
    v_add_f32 v168, v168, v170
    v_cndmask_b32 v164, v164, v165, s[68:69]
    v_mov_b32 v12, v168
    v_mfma_f32_32x32x16_bf16 v[32:47], v[52:55], v[68:71], v[32:47]
    s_nop 0
    v_permlane32_swap_b32 v168, v12
    v_add_f32 v165, v168, v12
    ds_write_b64 v180, v[164:165]
    s_waitcnt vmcnt(2) lgkmcnt(0)
    s_barrier
    ds_read_b64 v[90:91], v181
    ds_read_b128 v[96:99], v182
    v_mfma_f32_32x32x16_bf16 v[32:47], v[56:59], v[72:75], v[32:47]
    v_mfma_f32_32x32x16_bf16 v[32:47], v[60:63], v[76:79], v[32:47]
    s_waitcnt lgkmcnt(1)
    v_add_f32 v90, v90, v164
    v_add_f32 v91, v91, v165
    v_mul_f32 v90, 0x3b124925, v90
    s_waitcnt lgkmcnt(0)
    v_add_f32 v96, v96, v97
    v_add_f32 v98, v98, v99
    v_mul_f32 v91, 0x3b124925, v91
    v_add_f32 v96, v96, v98
    s_mov_b32 exec_hi, 0
    v_cvt_pk_bf16_f32 v80, -v90, -v90
    s_mov_b32 exec_hi, -1
    v_and_b32 v97, 0xffff0000, v96
    v_fma_f32 v91, -v90, v90, v91
    v_sub_f32 v98, v96, v97
    v_cvt_pk_bf16_f32 v84, v97, v98
    v_max_f32 v91, 0, v91
    v_cvt_pk_bf16_f32 v91, v91, v91
    v_mfma_f32_32x32x16_bf16 v[32:47], v[80:83], v[84:87], v[32:47]
    v_and_b32 v91, 0xffff0000, v91
    v_add_f32 v91, 0x3727c5ac, v91
    v_cvt_pk_bf16_f32 v91, v91, v91
    v_and_b32 v91, 0xffff0000, v91
    v_sqrt_f32 v91, v91
    s_cmp_eq_u32 s45, 7
    v_cvt_pk_bf16_f32 v91, v91, v91
    v_and_b32 v91, 0xffff0000, v91
    v_rcp_f32 v88, v91
    s_cbranch_scc1 L_padwg
    ds_write_b32 v30, v88
    ds_read_b128 v[64:67], v31 offset:0
    ds_read_b128 v[68:71], v31 offset:32
    ds_read_b128 v[72:75], v31 offset:64
    ds_read_b128 v[76:79], v31 offset:96
    s_waitcnt lgkmcnt(3)
    v_pk_mul_f32 v[32:33], v[32:33], v[64:65]
    v_pk_mul_f32 v[34:35], v[34:35], v[66:67]
    s_waitcnt lgkmcnt(2)
    v_pk_mul_f32 v[36:37], v[36:37], v[68:69]
    v_pk_mul_f32 v[38:39], v[38:39], v[70:71]
    s_waitcnt lgkmcnt(1)
    v_pk_mul_f32 v[40:41], v[40:41], v[72:73]
    v_pk_mul_f32 v[42:43], v[42:43], v[74:75]
    s_waitcnt lgkmcnt(0)
    v_pk_mul_f32 v[44:45], v[44:45], v[76:77]
    v_pk_mul_f32 v[46:47], v[46:47], v[78:79]
    v_cvt_pk_bf16_f32 v48, v32, v33
    v_cvt_pk_bf16_f32 v49, v34, v35
    v_cvt_pk_bf16_f32 v50, v36, v37
    v_cvt_pk_bf16_f32 v51, v38, v39
    v_cvt_pk_bf16_f32 v52, v40, v41
    v_cvt_pk_bf16_f32 v53, v42, v43
    v_cvt_pk_bf16_f32 v54, v44, v45
    v_cvt_pk_bf16_f32 v55, v46, v47
    buffer_store_dwordx4 v[48:51], v29, s[20:23], 0 offen offset:2048 sc1
    buffer_store_dwordx4 v[52:55], v29, s[20:23], 0 offen offset:3072 sc1
L_7:
    s_mov_b64 exec, -1
L_qpass:
    s_sub_u32 s53, s42, 1
    s_lshl_b32 s53, s53, 16
    s_lshl_b32 s54, s42, 14
    s_lshl_b32 s51, s62, 10
    s_add_u32 s54, s54, s51
    s_add_u32 s54, s54, 122880
    v_add_u32 v20, s54, v24
    v_add_u32 v16, s53, v16
    v_add_u32 v17, s53, v17
    v_xor_b32 v21, 1024, v20
    v_add_u32 v18, s53, v18
    v_xor_b32 v22, 2048, v20
    v_add_u32 v19, s53, v19
    v_xor_b32 v23, 3072, v20
    ds_read_b128 v[96:99], v16 offset:0
    ds_read_b64_tr_b16 v[112:113], v20 offset:0
    ds_read_b64_tr_b16 v[114:115], v20 offset:256
    ds_read_b128 v[100:103], v17 offset:0
    ds_read_b64_tr_b16 v[116:117], v21 offset:0
    ds_read_b64_tr_b16 v[118:119], v21 offset:256
    ds_read_b128 v[104:107], v18 offset:0
    ds_read_b64_tr_b16 v[120:121], v22 offset:0
    ds_read_b64_tr_b16 v[122:123], v22 offset:256
    ds_read_b128 v[108:111], v19 offset:0
    ds_read_b64_tr_b16 v[124:125], v23 offset:0
    ds_read_b64_tr_b16 v[126:127], v23 offset:256
    s_waitcnt lgkmcnt(9)
    v_mfma_f32_32x32x16_bf16 v[32:47], v[112:115], v[96:99], 0
    v_mfma_f32_16x16x32_bf16 v[172:175], v[176:179], v[112:115], 0
    ds_read_b128 v[96:99], v16 offset:16384
    ds_read_b64_tr_b16 v[112:113], v20 offset:4096
    ds_read_b64_tr_b16 v[114:115], v20 offset:4352
    v_lshlrev_b32 v163, 10, v1
    v_lshlrev_b32 v162, 8, v1
    v_mul_u32_u24 v14, 28, v1
    s_lshl_b32 s52, s45, 6
    s_add_u32 s53, s52, 63
    v_add_u32 v15, 27, v14
    v_cmp_ge_u32 s[70:71], s53, v14
    v_cmp_le_u32 vcc, s52, v15
    v_mov_b32 v188, -1
    v_mov_b32 v189, -1
    v_mov_b32 v190, -1
    v_mov_b32 v191, -1
    s_waitcnt lgkmcnt(9)
    v_mfma_f32_32x32x16_bf16 v[32:47], v[116:119], v[100:103], v[32:47]
    ds_read_b128 v[100:103], v17 offset:16384
    ds_read_b64_tr_b16 v[116:117], v21 offset:4096
    ds_read_b64_tr_b16 v[118:119], v21 offset:4352
    s_and_b32 s70, s70, vcc_lo
    s_and_b32 s70, s70, 0xffff
    s_lshl_b32 s52, s46, 3
    s_lshl_b32 s52, 0xff, s52
    s_cmp_eq_u32 s45, 7
    s_cselect_b32 s70, s52, s70
    s_mov_b32 s71, 0
    s_lshl_b32 s52, s43, 18
    s_add_u32 s52, s52, s56
    v_add_u32 v5, s52, v2
    s_and_b32 s58, s44, 12
    s_lshl_b32 s58, s58, 14
    s_waitcnt lgkmcnt(6)
    v_mfma_f32_32x32x16_bf16 v[32:47], v[120:123], v[104:107], v[32:47]
    ds_read_b128 v[104:107], v18 offset:16384
    ds_read_b64_tr_b16 v[120:121], v22 offset:4096
    ds_read_b64_tr_b16 v[122:123], v22 offset:4352
    s_lshr_b32 s59, s44, 2
    s_lshl_b32 s59, s59, 8
    s_lshl_b32 s52, s43, 10
    s_cmp_eq_u32 s40, 7
    s_cselect_b32 s59, s52, s59
    s_add_u32 s59, s59, 8388608
    s_mul_i32 s52, s43, 28
    s_add_u32 s53, s52, 27
    s_xor_b32 s52, s52, s53
    s_cmp_lt_u32 s52, 64
    s_cselect_b32 s63, 12, 20
    s_nop 0
    v_mfma_f32_32x32x16_bf16 v[32:47], v[124:127], v[108:111], v[32:47]
    ds_read_b128 v[108:111], v19 offset:16384
    ds_read_b64_tr_b16 v[124:125], v23 offset:4096
    ds_read_b64_tr_b16 v[126:127], v23 offset:4352
    s_waitcnt lgkmcnt(6)
    v_mfma_f32_32x32x16_bf16 v[32:47], v[112:115], v[96:99], v[32:47]
    v_mfma_f32_16x16x32_bf16 v[172:175], v[176:179], v[112:115], v[172:175]
    v_mfma_f32_32x32x16_bf16 v[32:47], v[116:119], v[100:103], v[32:47]
    s_waitcnt lgkmcnt(0)
    v_mfma_f32_32x32x16_bf16 v[32:47], v[120:123], v[104:107], v[32:47]
    s_waitcnt vmcnt(0)
    s_mov_b32 s55, 0x20000
    s_mov_b64 exec, 0xffff
L_10:
    v_cmp_ne_u32 vcc, 1, v160
    s_cbranch_vccz L_11
    v_lshlrev_b32 v14, 2, v1
    buffer_load_dword v160, v14, s[28:31], 0 offen offset:128 sc1
    s_sub_u32 s55, s55, 1
    s_waitcnt vmcnt(0)
    s_cbranch_scc0 L_10
L_11:
    s_mov_b64 exec, -1
    s_barrier
    s_cmp_lg_u32 s40, 0
    s_cbranch_scc1 L_9
    s_mov_b64 exec, s[70:71]
    buffer_atomic_add v160, v163, s[20:23], s59 offen sc1
    s_mov_b64 exec, -1
L_9:
    ds_read_b128 v[96:99], v16 offset:32768
    ds_read_b64_tr_b16 v[112:113], v20 offset:8192
    ds_read_b64_tr_b16 v[114:115], v20 offset:8448
    ds_read_b128 v[100:103], v17 offset:32768
    ds_read_b64_tr_b16 v[116:117], v21 offset:8192
    ds_read_b64_tr_b16 v[118:119], v21 offset:8448
    ds_read_b128 v[104:107], v18 offset:32768
    ds_read_b64_tr_b16 v[120:121], v22 offset:8192
    ds_read_b64_tr_b16 v[122:123], v22 offset:8448
    v_mfma_f32_32x32x16_bf16 v[32:47], v[124:127], v[108:111], v[32:47]
    ds_read_b128 v[108:111], v19 offset:32768
    ds_read_b64_tr_b16 v[124:125], v23 offset:8192
    ds_read_b64_tr_b16 v[126:127], v23 offset:8448
    s_lshl_b32 s52, s42, 15
    s_lshl_b32 s53, s41, 12
    s_add_u32 s53, s53, 32768
    s_add_u32 s54, s53, s52
    v_add_u32 v185, s54, v2
    s_xor_b32 s52, s52, 32768
    s_add_u32 s54, s53, s52
    v_add_u32 v186, s54, v2
    v_lshlrev_b32 v13, 5, v3
    v_add_u32 v187, 159744, v13
    v_lshl_add_u32 v192, s40, 2, v187
    v_lshlrev_b32 v184, 4, v0
    s_cmp_lg_u32 s40, 7
    s_cbranch_scc1 L_12
    s_mov_b64 exec, 15
    v_mov_b32 v161, 0
    buffer_atomic_add v161, v162, s[20:23], s59 offen sc0 sc1
    s_mov_b64 exec, -1
L_12:
    s_waitcnt lgkmcnt(6)
    v_mfma_f32_32x32x16_bf16 v[32:47], v[112:115], v[96:99], v[32:47]
    v_mfma_f32_16x16x32_bf16 v[172:175], v[176:179], v[112:115], v[172:175]
    ds_read_b128 v[96:99], v16 offset:49152
    ds_read_b64_tr_b16 v[112:113], v20 offset:12288
    ds_read_b64_tr_b16 v[114:115], v20 offset:12544
    s_lshl_b32 s52, s81, 14
    s_add_u32 s52, s52, 4194304
    buffer_store_dwordx4 v[188:191], v184, s[20:23], s52 offen sc1
    s_lshl_b32 s52, s81, 14
    s_add_u32 s52, s52, 4202496
    buffer_store_dwordx4 v[188:191], v184, s[20:23], s52 offen sc1
    s_lshl_b32 s52, s81, 12
    s_add_u32 s52, s52, 10485760
    s_cmp_lt_u32 s40, 4
    s_cselect_b32 s52, s52, 0x40000000
    buffer_store_dwordx4 v[188:191], v184, s[20:23], s52 offen sc1
    v_mfma_f32_32x32x16_bf16 v[32:47], v[116:119], v[100:103], v[32:47]
    ds_read_b128 v[100:103], v17 offset:49152
    ds_read_b64_tr_b16 v[116:117], v21 offset:12288
    ds_read_b64_tr_b16 v[118:119], v21 offset:12544
    s_waitcnt lgkmcnt(6)
    v_mfma_f32_32x32x16_bf16 v[32:47], v[120:123], v[104:107], v[32:47]
    ds_read_b128 v[104:107], v18 offset:49152
    ds_read_b64_tr_b16 v[120:121], v22 offset:12288
    ds_read_b64_tr_b16 v[122:123], v22 offset:12544
    v_mfma_f32_32x32x16_bf16 v[32:47], v[124:127], v[108:111], v[32:47]
    ds_read_b128 v[108:111], v19 offset:49152
    ds_read_b64_tr_b16 v[124:125], v23 offset:12288
    ds_read_b64_tr_b16 v[126:127], v23 offset:12544
    s_cmp_eq_u32 s42, 1
    s_cbranch_scc1 L_8
    s_waitcnt lgkmcnt(6)
    v_mfma_f32_32x32x16_bf16 v[32:47], v[112:115], v[96:99], v[32:47]
    v_mfma_f32_16x16x32_bf16 v[172:175], v[176:179], v[112:115], v[172:175]
    v_mfma_f32_32x32x16_bf16 v[32:47], v[116:119], v[100:103], v[32:47]
    s_waitcnt lgkmcnt(0)
    v_mfma_f32_32x32x16_bf16 v[32:47], v[120:123], v[104:107], v[32:47]
    v_mfma_f32_32x32x16_bf16 v[32:47], v[124:127], v[108:111], v[32:47]
L_8:
    s_nop 3
    v_cndmask_b32 v172, v172, v173, s[68:69]
    s_nop 6
    ds_write_b32 v192, v172
    ds_write_b128 v185, v[32:35] offset:0
    ds_write_b128 v185, v[36:39] offset:1024
    ds_write_b128 v185, v[40:43] offset:2048
    ds_write_b128 v185, v[44:47] offset:3072
    s_cmp_lg_u32 s40, 7
    s_cbranch_scc1 L_14
    s_mov_b64 exec, 15
    s_mov_b32 s55, 0x20000
    s_waitcnt vmcnt(3)
L_13:
    v_cmp_gt_u32 vcc, s63, v161
    s_cbranch_vccz L_14
    s_sub_u32 s55, s55, 1
    s_cbranch_scc1 L_14
    v_mov_b32 v161, 0
    buffer_atomic_add v161, v162, s[20:23], s59 offen sc0 sc1
    s_waitcnt vmcnt(0)
    s_branch L_13
L_14:
    s_mov_b64 exec, -1
    s_waitcnt lgkmcnt(0)
    s_barrier
    s_add_u32 m0, s56, 49152
    s_mov_b32 s51, s58
    buffer_load_dwordx4 v5, s[20:23], s51 offen offset:0 sc1 lds
    buffer_load_dwordx4 v5, s[20:23], s51 offen offset:1024 sc1 lds
    ds_read_b128 v[92:95], v187
    ds_read_b128 v[96:99], v187 offset:16
    ds_read_b128 v[112:115], v186 offset:0
    ds_read_b128 v[116:119], v186 offset:1024
    ds_read_b128 v[120:123], v186 offset:2048
    ds_read_b128 v[124:127], v186 offset:3072
    s_waitcnt lgkmcnt(4)
    v_add_f32 v92, v92, v93
    v_add_f32 v94, v94, v95
    v_add_f32 v96, v96, v97
    v_add_f32 v98, v98, v99
    v_add_f32 v92, v92, v94
    v_add_f32 v96, v96, v98
    v_add_f32 v92, v92, v96
    v_and_b32 v93, 0xffff0000, v92
    v_sub_f32 v94, v92, v93
    v_cvt_pk_bf16_f32 v84, v93, v94
    v_mul_f32 v88, 0x3e8b97f6, v88
    s_and_b32 s52, s43, 1
    v_mfma_f32_32x32x16_bf16 v[32:47], v[84:87], v[80:83], v[32:47]
    s_sub_u32 s65, s52, 1
    s_mov_b32 s64, 0
    s_sub_u32 s66, 0, s52
    s_mov_b32 s67, 0
    s_mov_b32 s63, 0
    s_nop 3
    s_waitcnt lgkmcnt(0)
    s_nop 1
    v_pk_add_f32 v[32:33], v[32:33], v[112:113]
    v_pk_add_f32 v[34:35], v[34:35], v[114:115]
    v_pk_add_f32 v[36:37], v[36:37], v[116:117]
    v_pk_add_f32 v[38:39], v[38:39], v[118:119]
    v_pk_add_f32 v[40:41], v[40:41], v[120:121]
    v_pk_add_f32 v[42:43], v[42:43], v[122:123]
    v_pk_add_f32 v[44:45], v[44:45], v[124:125]
    v_pk_add_f32 v[46:47], v[46:47], v[126:127]
    s_mov_b32 m0, s56
    s_xor_b32 s51, s58, 16384
    buffer_load_dwordx4 v5, s[20:23], s51 offen offset:0 sc1 lds
    buffer_load_dwordx4 v5, s[20:23], s51 offen offset:1024 sc1 lds
    v_pk_mul_f32 v[32:33], v[32:33], v[88:89] op_sel_hi:[1,0]
    v_pk_mul_f32 v[34:35], v[34:35], v[88:89] op_sel_hi:[1,0]
    v_pk_mul_f32 v[36:37], v[36:37], v[88:89] op_sel_hi:[1,0]
    v_pk_mul_f32 v[38:39], v[38:39], v[88:89] op_sel_hi:[1,0]
    v_pk_mul_f32 v[40:41], v[40:41], v[88:89] op_sel_hi:[1,0]
    v_pk_mul_f32 v[42:43], v[42:43], v[88:89] op_sel_hi:[1,0]
    v_pk_mul_f32 v[44:45], v[44:45], v[88:89] op_sel_hi:[1,0]
    v_pk_mul_f32 v[46:47], v[46:47], v[88:89] op_sel_hi:[1,0]
    v_cvt_pk_bf16_f32 v96, v32, v33
    v_cvt_pk_bf16_f32 v97, v34, v35
    v_cvt_pk_bf16_f32 v98, v36, v37
    v_cvt_pk_bf16_f32 v99, v38, v39
    v_cvt_pk_bf16_f32 v100, v40, v41
    v_cvt_pk_bf16_f32 v101, v42, v43
    v_cvt_pk_bf16_f32 v102, v44, v45
    v_cvt_pk_bf16_f32 v103, v46, v47
    v_permlane32_swap_b32 v96, v98
    v_permlane32_swap_b32 v97, v99
    v_permlane32_swap_b32 v100, v102
    v_permlane32_swap_b32 v101, v103
    v_cndmask_b32 v96, v96, 0, s[66:67]
    v_cndmask_b32 v97, v97, 0, s[66:67]
    v_cndmask_b32 v102, v102, 0, s[64:65]
    v_cndmask_b32 v103, v103, 0, s[64:65]
    s_add_u32 m0, s56, 16384
    s_xor_b32 s51, s58, 32768
    buffer_load_dwordx4 v5, s[20:23], s51 offen offset:0 sc1 lds
    buffer_load_dwordx4 v5, s[20:23], s51 offen offset:1024 sc1 lds
    v_lshl_add_u32 v6, s42, 13, v2
    s_min_u32 s57, s40, 6
    v_lshl_add_u32 v12, s57, 6, v1
    v_mul_u32_u24 v10, 4682, v12
    v_lshrrev_b32 v10, 16, v10
    v_mul_u32_u24 v11, 14, v10
    v_sub_u32 v11, v12, v11
    v_mul_u32_u24 v10, 896, v10
    v_lshl_add_u32 v10, v11, 4, v10
    s_mul_i32 s52, s48, 224
    v_add_u32 v78, s52, v10
    s_cmp_eq_u32 s40, 7
    s_cselect_b32 s53, 0x40000000, 0
    v_add_u32 v7, s53, v78
    s_lshl_b32 s57, s57, 10
    s_add_u32 s57, s57, 58368
    s_mov_b32 s70, 0x07060302
    v_mov_b32 v18, 0xdddddddd
    v_lshlrev_b32 v71, 4, v0
    v_lshlrev_b32 v16, 10, v1
    s_lshl_b32 s53, s40, 5
    v_lshrrev_b32 v12, 4, v1
    v_lshl_add_u32 v13, v12, 3, s53
    v_add_u32 v17, s52, v13
    v_lshl_add_u32 v59, s40, 12, v2
    v_xor_b32 v69, 16384, v59
    s_lshl_b32 s72, s44, 10
    s_add_u32 s72, s72, 8388736
    s_cmp_eq_u32 s40, 0
    s_cselect_b32 s72, s72, 0x40000000
    s_lshl_b32 s60, s44, 2
    s_add_u32 s60, s60, s41
    s_lshl_b32 s60, s60, 4
    s_add_u32 s60, s60, s43
    s_lshl_b32 s60, s60, 1
    s_add_u32 s60, s60, s42
    s_lshl_b32 s60, s60, 10
    s_add_u32 s60, s60, 4194304
    s_mov_b32 s18, 401408
    s_mov_b32 s19, 0x20000
    s_mov_b32 s34, 896
    s_mov_b32 s35, 0x20000
    s_mov_b32 s36, s82
    s_mov_b32 s37, s83
    s_mov_b32 s38, 0
    s_mov_b32 s39, 0x20000
    s_mov_b32 s8, s82
    s_mov_b32 s9, s83
    s_mov_b32 s10, 0
    s_mov_b32 s49, 0
    s_mov_b32 s50, 0
    v_mov_b32 v8, 0
    s_cmp_ge_u32 s81, 56
    s_cbranch_scc1 L_norole
    s_and_b32 s3, s81, 7
    s_lshr_b32 s51, s81, 3
    s_mul_i32 s50, s3, 7
    s_add_u32 s50, s50, s51
    s_mov_b32 s49, 1
    s_cmp_lt_u32 s40, 4
    s_cselect_b32 s36, s76, s78
    s_cselect_b32 s37, s77, s79
    s_mov_b32 s38, 1605632
    s_mov_b32 s10, 1605632
    s_mul_i32 s52, s41, 112
    v_lshrrev_b32 v10, 2, v1
    v_add_u32 v10, s52, v10
    v_mul_u32_u24 v10, 3584, v10
    v_lshlrev_b32 v11, 1, v4
    v_and_b32 v12, 3, v0
    v_xor_b32 v11, v11, v12
    v_lshl_add_u32 v10, v11, 4, v10
    s_lshl_b32 s52, s50, 6
    v_add_u32 v8, s52, v10
L_norole:
    s_lshl_b32 s73, s50, 3
    s_add_u32 s73, s73, s40
    s_mul_i32 s73, s73, 3584
L_attn:
    v_mov_b32 v152, 0
    v_mov_b32 v153, 0
    v_mov_b32 v154, 0
    v_mov_b32 v155, 0
    v_mov_b32 v156, 0
    v_mov_b32 v157, 0
    v_mov_b32 v158, 0
    v_mov_b32 v159, 0
    v_mov_b32 v160, 0
    v_mov_b32 v161, 0
    v_mov_b32 v162, 0
    v_mov_b32 v163, 0
    v_mov_b32 v164, 0
    v_mov_b32 v165, 0
    v_mov_b32 v166, 0
    v_mov_b32 v167, 0
    s_waitcnt vmcnt(4)
    s_barrier
    ds_read_b128 v[168:171], v6 offset:49152
    ds_read_b128 v[172:175], v6 offset:50176
    ds_read_b128 v[176:179], v6 offset:53248
    ds_read_b128 v[180:183], v6 offset:54272
    s_waitcnt lgkmcnt(3)
    v_mfma_f32_32x32x16_bf16 v[104:119], v[168:171], v[96:99], 0
    s_waitcnt lgkmcnt(2)
    v_mfma_f32_32x32x16_bf16 v[104:119], v[172:175], v[100:103], v[104:119]
    ds_read_b128 v[184:187], v6 offset:51200
    ds_read_b128 v[188:191], v6 offset:52224
    ds_read_b128 v[192:195], v6 offset:55296
    ds_read_b128 v[196:199], v6 offset:56320
    v_add_u32 v14, 158720, v2
    v_mov_b32 v15, 160800
    v_mov_b32 v12, 122880
    v_mov_b32 v13, 0
    ds_write_b128 v14, v[152:155]
    ds_write_b64 v15, v[12:13]
    s_cmp_eq_u32 s63, 1
    s_cbranch_scc1 L_15
    v_max3_f32 v10, v104, v105, v106
    v_max3_f32 v11, v107, v108, v109
    v_max3_f32 v12, v110, v111, v112
    v_max3_f32 v13, v113, v114, v115
    v_max3_f32 v10, v10, v116, v117
    v_max3_f32 v11, v11, v118, v119
    v_max3_f32 v10, v10, v12, v13
    v_max_f32 v19, v10, v11
    v_mov_b32 v11, v19
    s_nop 1
    v_permlane32_swap_b32 v19, v11
    v_max_f32 v19, v19, v11
L_15:
    v_xor_b32 v10, 0x80000000, v19
    v_and_b32 v11, 0xffff0000, v10
    v_sub_f32 v12, v10, v11
    v_and_b32 v13, 0xffff0000, v12
    v_perm_b32 v11, v12, v10, s70
    v_sub_f32 v14, v12, v13
    v_lshrrev_b32 v14, 16, v14
    v_cndmask_b32 v96, v96, v11, s[66:67]
    v_cndmask_b32 v97, v97, v14, s[66:67]
    v_cndmask_b32 v102, v102, v11, s[64:65]
    v_cndmask_b32 v103, v103, v14, s[64:65]
    v_pk_add_f32 v[104:105], v[104:105], v[10:11] op_sel_hi:[1,0]
    v_pk_add_f32 v[106:107], v[106:107], v[10:11] op_sel_hi:[1,0]
    v_pk_add_f32 v[108:109], v[108:109], v[10:11] op_sel_hi:[1,0]
    v_pk_add_f32 v[110:111], v[110:111], v[10:11] op_sel_hi:[1,0]
    v_pk_add_f32 v[112:113], v[112:113], v[10:11] op_sel_hi:[1,0]
    v_pk_add_f32 v[114:115], v[114:115], v[10:11] op_sel_hi:[1,0]
    v_pk_add_f32 v[116:117], v[116:117], v[10:11] op_sel_hi:[1,0]
    v_pk_add_f32 v[118:119], v[118:119], v[10:11] op_sel_hi:[1,0]
    s_waitcnt lgkmcnt(7)
    v_mfma_f32_32x32x16_bf16 v[120:135], v[176:179], v[96:99], 0
    s_add_u32 m0, s56, 32768
    s_xor_b32 s51, s58, 49152
    buffer_load_dwordx4 v5, s[20:23], s51 offen offset:0 sc1 lds
    buffer_load_dwordx4 v5, s[20:23], s51 offen offset:1024 sc1 lds
    s_cmp_eq_u32 s49, 1
    s_cbranch_scc1 L_loopf
    s_cmp_eq_u32 s42, 1
    s_cbranch_scc1 L_loop1
    s_waitcnt vmcnt(4) lgkmcnt(0)
    s_barrier
    ds_read_b128 v[200:203], v6 offset:0
    ds_read_b128 v[204:207], v6 offset:1024
    v_exp_f32 v104, v104
    v_exp_f32 v105, v105
    v_exp_f32 v106, v106
    v_exp_f32 v107, v107
    v_exp_f32 v108, v108
    v_exp_f32 v109, v109
    v_mfma_f32_32x32x16_bf16 v[120:135], v[180:183], v[100:103], v[120:135]
    ds_read_b128 v[208:211], v6 offset:4096
    ds_read_b128 v[212:215], v6 offset:5120
    v_exp_f32 v110, v110
    v_exp_f32 v111, v111
    v_exp_f32 v112, v112
    v_exp_f32 v113, v113
    v_smfmac_f32_32x32x32_bf16 v[152:167], v[184:187], v[104:111], v18
    ds_read_b128 v[216:219], v6 offset:2048
    ds_read_b128 v[220:223], v6 offset:3072
    v_exp_f32 v114, v114
    v_exp_f32 v115, v115
    v_exp_f32 v116, v116
    v_exp_f32 v117, v117
    s_waitcnt lgkmcnt(2)
    v_mfma_f32_32x32x16_bf16 v[136:151], v[200:203], v[96:99], 0
    v_exp_f32 v118, v118
    v_exp_f32 v119, v119
    v_exp_f32 v120, v120
    s_add_u32 m0, s56, 49152
    s_xor_b32 s51, s58, 65536
    v_exp_f32 v121, v121
    v_smfmac_f32_32x32x32_bf16 v[152:167], v[188:191], v[112:119], v18
    buffer_load_dwordx4 v5, s[20:23], s51 offen offset:0 sc1 lds
    v_exp_f32 v122, v122
    v_exp_f32 v123, v123
    v_exp_f32 v124, v124
    v_exp_f32 v125, v125
    v_mfma_f32_32x32x16_bf16 v[136:151], v[204:207], v[100:103], v[136:151]
    ds_read_b128 v[224:227], v6 offset:6144
    ds_read_b128 v[228:231], v6 offset:7168
    buffer_load_dwordx4 v5, s[20:23], s51 offen offset:1024 sc1 lds
    v_exp_f32 v126, v126
    v_exp_f32 v127, v127
    v_exp_f32 v128, v128
    s_add_u32 m0, s56, 57344
    s_xor_b32 s51, s58, 73728
    v_exp_f32 v129, v129
    v_smfmac_f32_32x32x32_bf16 v[152:167], v[192:195], v[120:127], v18
    buffer_load_dwordx4 v5, s[20:23], s51 offen offset:0 sc1 lds
    v_exp_f32 v130, v130
    v_exp_f32 v131, v131
    v_exp_f32 v132, v132
    v_exp_f32 v133, v133
    v_mfma_f32_32x32x16_bf16 v[104:119], v[208:211], v[96:99], 0
    buffer_load_dwordx4 v5, s[20:23], s51 offen offset:1024 sc1 lds
    v_exp_f32 v134, v134
    v_exp_f32 v135, v135
    s_waitcnt vmcnt(6) lgkmcnt(0)
    s_barrier
    ds_read_b128 v[168:171], v6 offset:16384
    ds_read_b128 v[172:175], v6 offset:17408
    v_exp_f32 v136, v136
    v_exp_f32 v137, v137
    v_smfmac_f32_32x32x32_bf16 v[152:167], v[196:199], v[128:135], v18
    v_exp_f32 v138, v138
    v_exp_f32 v139, v139
    v_exp_f32 v140, v140
    v_exp_f32 v141, v141
    v_mfma_f32_32x32x16_bf16 v[104:119], v[212:215], v[100:103], v[104:119]
    ds_read_b128 v[176:179], v6 offset:20480
    ds_read_b128 v[180:183], v6 offset:21504
    v_exp_f32 v142, v142
    v_exp_f32 v143, v143
    v_exp_f32 v144, v144
    v_exp_f32 v145, v145
    v_smfmac_f32_32x32x32_bf16 v[152:167], v[216:219], v[136:143], v18
    ds_read_b128 v[184:187], v6 offset:18432
    ds_read_b128 v[188:191], v6 offset:19456
    s_add_u32 s52, s40, s63
    s_cmp_lg_u32 s52, 0
    s_cbranch_scc1 L_16
    s_lshl_b32 s52, s43, 10
    s_add_u32 s52, s52, 8388612
    s_mov_b64 exec, 1
    v_mov_b32 v10, 1
    buffer_atomic_add v10, v2, s[20:23], s52 offen sc1
    s_mov_b64 exec, -1
L_16:
    v_exp_f32 v146, v146
    v_exp_f32 v147, v147
    v_exp_f32 v148, v148
    v_exp_f32 v149, v149
    s_waitcnt lgkmcnt(2)
    v_mfma_f32_32x32x16_bf16 v[120:135], v[168:171], v[96:99], 0
    v_exp_f32 v150, v150
    v_exp_f32 v151, v151
    v_exp_f32 v104, v104
    s_mov_b32 m0, s56
    s_xor_b32 s51, s58, 81920
    v_exp_f32 v105, v105
    v_smfmac_f32_32x32x32_bf16 v[152:167], v[220:223], v[144:151], v18
    buffer_load_dwordx4 v5, s[20:23], s51 offen offset:0 sc1 lds
    v_exp_f32 v106, v106
    v_exp_f32 v107, v107
    v_exp_f32 v108, v108
    v_exp_f32 v109, v109
    v_mfma_f32_32x32x16_bf16 v[120:135], v[172:175], v[100:103], v[120:135]
    ds_read_b128 v[192:195], v6 offset:22528
    ds_read_b128 v[196:199], v6 offset:23552
    buffer_load_dwordx4 v5, s[20:23], s51 offen offset:1024 sc1 lds
    v_exp_f32 v110, v110
    v_exp_f32 v111, v111
    v_exp_f32 v112, v112
    s_add_u32 m0, s56, 8192
    s_xor_b32 s51, s58, 90112
    v_exp_f32 v113, v113
    v_smfmac_f32_32x32x32_bf16 v[152:167], v[224:227], v[104:111], v18
    buffer_load_dwordx4 v5, s[20:23], s51 offen offset:0 sc1 lds
    v_exp_f32 v114, v114
    v_exp_f32 v115, v115
    v_exp_f32 v116, v116
    v_exp_f32 v117, v117
    v_mfma_f32_32x32x16_bf16 v[136:151], v[176:179], v[96:99], 0
    buffer_load_dwordx4 v5, s[20:23], s51 offen offset:1024 sc1 lds
    v_exp_f32 v118, v118
    v_exp_f32 v119, v119
    s_waitcnt vmcnt(8) lgkmcnt(0)
    s_barrier
    ds_read_b128 v[200:203], v6 offset:32768
    ds_read_b128 v[204:207], v6 offset:33792
    v_exp_f32 v120, v120
    v_exp_f32 v121, v121
    v_smfmac_f32_32x32x32_bf16 v[152:167], v[228:231], v[112:119], v18
    v_exp_f32 v122, v122
    v_exp_f32 v123, v123
    v_exp_f32 v124, v124
    v_exp_f32 v125, v125
    v_mfma_f32_32x32x16_bf16 v[136:151], v[180:183], v[100:103], v[136:151]
    ds_read_b128 v[208:211], v6 offset:36864
    ds_read_b128 v[212:215], v6 offset:37888
    v_exp_f32 v126, v126
    v_exp_f32 v127, v127
    v_exp_f32 v128, v128
    v_exp_f32 v129, v129
    v_smfmac_f32_32x32x32_bf16 v[152:167], v[184:187], v[120:127], v18
    ds_read_b128 v[216:219], v6 offset:34816
    ds_read_b128 v[220:223], v6 offset:35840
    v_exp_f32 v130, v130
    v_exp_f32 v131, v131
    v_exp_f32 v132, v132
    v_exp_f32 v133, v133
    s_waitcnt lgkmcnt(2)
    v_mfma_f32_32x32x16_bf16 v[104:119], v[200:203], v[96:99], 0
    v_exp_f32 v134, v134
    v_exp_f32 v135, v135
    v_exp_f32 v136, v136
    s_add_u32 m0, s56, 16384
    s_xor_b32 s51, s58, 98304
    v_exp_f32 v137, v137
    v_smfmac_f32_32x32x32_bf16 v[152:167], v[188:191], v[128:135], v18
    buffer_load_dwordx4 v5, s[20:23], s51 offen offset:0 sc1 lds
    v_exp_f32 v138, v138
    v_exp_f32 v139, v139
    v_exp_f32 v140, v140
    v_exp_f32 v141, v141
    v_mfma_f32_32x32x16_bf16 v[104:119], v[204:207], v[100:103], v[104:119]
    ds_read_b128 v[224:227], v6 offset:38912
    ds_read_b128 v[228:231], v6 offset:39936
    buffer_load_dwordx4 v5, s[20:23], s51 offen offset:1024 sc1 lds
    v_exp_f32 v142, v142
    v_exp_f32 v143, v143
    v_exp_f32 v144, v144
    s_add_u32 m0, s56, 24576
    s_xor_b32 s51, s58, 106496
    v_exp_f32 v145, v145
    v_smfmac_f32_32x32x32_bf16 v[152:167], v[192:195], v[136:143], v18
    buffer_load_dwordx4 v5, s[20:23], s51 offen offset:0 sc1 lds
    v_exp_f32 v146, v146
    v_exp_f32 v147, v147
    v_exp_f32 v148, v148
    v_exp_f32 v149, v149
    v_mfma_f32_32x32x16_bf16 v[120:135], v[208:211], v[96:99], 0
    buffer_load_dwordx4 v5, s[20:23], s51 offen offset:1024 sc1 lds
    v_exp_f32 v150, v150
    v_exp_f32 v151, v151
    s_waitcnt vmcnt(8) lgkmcnt(0)
    s_barrier
    ds_read_b128 v[168:171], v6 offset:49152
    ds_read_b128 v[172:175], v6 offset:50176
    v_exp_f32 v104, v104
    v_exp_f32 v105, v105
    v_smfmac_f32_32x32x32_bf16 v[152:167], v[196:199], v[144:151], v18
    v_exp_f32 v106, v106
    v_exp_f32 v107, v107
    v_exp_f32 v108, v108
    v_exp_f32 v109, v109
    v_mfma_f32_32x32x16_bf16 v[120:135], v[212:215], v[100:103], v[120:135]
    ds_read_b128 v[176:179], v6 offset:53248
    ds_read_b128 v[180:183], v6 offset:54272
    v_exp_f32 v110, v110
    v_exp_f32 v111, v111
    v_exp_f32 v112, v112
    v_exp_f32 v113, v113
    v_smfmac_f32_32x32x32_bf16 v[152:167], v[216:219], v[104:111], v18
    ds_read_b128 v[184:187], v6 offset:51200
    ds_read_b128 v[188:191], v6 offset:52224
    v_exp_f32 v114, v114
    v_exp_f32 v115, v115
    v_exp_f32 v116, v116
    v_exp_f32 v117, v117
    s_waitcnt lgkmcnt(2)
    v_mfma_f32_32x32x16_bf16 v[136:151], v[168:171], v[96:99], 0
    v_exp_f32 v118, v118
    v_exp_f32 v119, v119
    v_exp_f32 v120, v120
    s_add_u32 m0, s56, 32768
    s_xor_b32 s51, s58, 114688
    v_exp_f32 v121, v121
    v_smfmac_f32_32x32x32_bf16 v[152:167], v[220:223], v[112:119], v18
    buffer_load_dwordx4 v5, s[20:23], s51 offen offset:0 sc1 lds
    v_exp_f32 v122, v122
    v_exp_f32 v123, v123
    v_exp_f32 v124, v124
    v_exp_f32 v125, v125
    v_mfma_f32_32x32x16_bf16 v[136:151], v[172:175], v[100:103], v[136:151]
    ds_read_b128 v[192:195], v6 offset:55296
    ds_read_b128 v[196:199], v6 offset:56320
    buffer_load_dwordx4 v5, s[20:23], s51 offen offset:1024 sc1 lds
    v_exp_f32 v126, v126
    v_exp_f32 v127, v127
    v_exp_f32 v128, v128
    s_add_u32 m0, s56, 40960
    s_xor_b32 s51, s58, 122880
    v_exp_f32 v129, v129
    v_smfmac_f32_32x32x32_bf16 v[152:167], v[224:227], v[120:127], v18
    buffer_load_dwordx4 v5, s[20:23], s51 offen offset:0 sc1 lds
    v_exp_f32 v130, v130
    v_exp_f32 v131, v131
    v_exp_f32 v132, v132
    v_exp_f32 v133, v133
    v_mfma_f32_32x32x16_bf16 v[104:119], v[176:179], v[96:99], 0
    buffer_load_dwordx4 v5, s[20:23], s51 offen offset:1024 sc1 lds
    v_exp_f32 v134, v134
    v_exp_f32 v135, v135
    s_waitcnt vmcnt(8) lgkmcnt(0)
    s_barrier
    ds_read_b128 v[200:203], v6 offset:0
    ds_read_b128 v[204:207], v6 offset:1024
    v_exp_f32 v136, v136
    v_exp_f32 v137, v137
    v_smfmac_f32_32x32x32_bf16 v[152:167], v[228:231], v[128:135], v18
    v_exp_f32 v138, v138
    v_exp_f32 v139, v139
    v_exp_f32 v140, v140
    v_exp_f32 v141, v141
    v_mfma_f32_32x32x16_bf16 v[104:119], v[180:183], v[100:103], v[104:119]
    ds_read_b128 v[208:211], v6 offset:4096
    ds_read_b128 v[212:215], v6 offset:5120
    v_exp_f32 v142, v142
    v_exp_f32 v143, v143
    v_exp_f32 v144, v144
    s_add_u32 m0, s57, 7168
    s_mov_b32 s59, 28672
    v_exp_f32 v145, v145
    v_smfmac_f32_32x32x32_bf16 v[152:167], v[184:187], v[136:143], v18
    ds_read_b128 v[216:219], v6 offset:2048
    ds_read_b128 v[220:223], v6 offset:3072
    buffer_load_dwordx4 v78, s[16:19], s59 offen lds
    v_exp_f32 v146, v146
    v_exp_f32 v147, v147
    v_exp_f32 v148, v148
    s_add_u32 m0, s57, 14336
    s_mov_b32 s59, 57344
    v_exp_f32 v149, v149
    s_waitcnt lgkmcnt(2)
    v_mfma_f32_32x32x16_bf16 v[120:135], v[200:203], v[96:99], 0
    buffer_load_dwordx4 v78, s[16:19], s59 offen lds
    v_exp_f32 v150, v150
    v_exp_f32 v151, v151
    v_exp_f32 v104, v104
    s_add_u32 m0, s56, 49152
    s_xor_b32 s51, s58, 131072
    v_exp_f32 v105, v105
    v_smfmac_f32_32x32x32_bf16 v[152:167], v[188:191], v[144:151], v18
    buffer_load_dwordx4 v5, s[20:23], s51 offen offset:0 sc1 lds
    v_exp_f32 v106, v106
    v_exp_f32 v107, v107
    v_exp_f32 v108, v108
    v_exp_f32 v109, v109
    v_mfma_f32_32x32x16_bf16 v[120:135], v[204:207], v[100:103], v[120:135]
    ds_read_b128 v[224:227], v6 offset:6144
    ds_read_b128 v[228:231], v6 offset:7168
    buffer_load_dwordx4 v5, s[20:23], s51 offen offset:1024 sc1 lds
    v_exp_f32 v110, v110
    v_exp_f32 v111, v111
    v_exp_f32 v112, v112
    s_add_u32 m0, s56, 57344
    s_xor_b32 s51, s58, 139264
    v_exp_f32 v113, v113
    v_smfmac_f32_32x32x32_bf16 v[152:167], v[192:195], v[104:111], v18
    buffer_load_dwordx4 v5, s[20:23], s51 offen offset:0 sc1 lds
    v_exp_f32 v114, v114
    v_exp_f32 v115, v115
    v_exp_f32 v116, v116
    v_exp_f32 v117, v117
    v_mfma_f32_32x32x16_bf16 v[136:151], v[208:211], v[96:99], 0
    buffer_load_dwordx4 v5, s[20:23], s51 offen offset:1024 sc1 lds
    v_exp_f32 v118, v118
    v_exp_f32 v119, v119
    s_waitcnt vmcnt(10) lgkmcnt(0)
    s_barrier
    ds_read_b128 v[168:171], v6 offset:16384
    ds_read_b128 v[172:175], v6 offset:17408
    v_exp_f32 v120, v120
    v_exp_f32 v121, v121
    v_smfmac_f32_32x32x32_bf16 v[152:167], v[196:199], v[112:119], v18
    v_exp_f32 v122, v122
    v_exp_f32 v123, v123
    v_exp_f32 v124, v124
    v_exp_f32 v125, v125
    v_mfma_f32_32x32x16_bf16 v[136:151], v[212:215], v[100:103], v[136:151]
    ds_read_b128 v[176:179], v6 offset:20480
    ds_read_b128 v[180:183], v6 offset:21504
    v_exp_f32 v126, v126
    v_exp_f32 v127, v127
    v_exp_f32 v128, v128
    s_add_u32 m0, s57, 21504
    s_mov_b32 s59, 86016
    v_exp_f32 v129, v129
    v_smfmac_f32_32x32x32_bf16 v[152:167], v[216:219], v[120:127], v18
    ds_read_b128 v[184:187], v6 offset:18432
    ds_read_b128 v[188:191], v6 offset:19456
    buffer_load_dwordx4 v78, s[16:19], s59 offen lds
    v_exp_f32 v130, v130
    v_exp_f32 v131, v131
    v_exp_f32 v132, v132
    v_exp_f32 v133, v133
    s_waitcnt lgkmcnt(2)
    v_mfma_f32_32x32x16_bf16 v[104:119], v[168:171], v[96:99], 0
    v_exp_f32 v134, v134
    v_exp_f32 v135, v135
    v_exp_f32 v136, v136
    s_mov_b32 m0, s56
    s_xor_b32 s51, s58, 147456
    v_exp_f32 v137, v137
    v_smfmac_f32_32x32x32_bf16 v[152:167], v[220:223], v[128:135], v18
    buffer_load_dwordx4 v5, s[20:23], s51 offen offset:0 sc1 lds
    v_exp_f32 v138, v138
    v_exp_f32 v139, v139
    v_exp_f32 v140, v140
    v_exp_f32 v141, v141
    v_mfma_f32_32x32x16_bf16 v[104:119], v[172:175], v[100:103], v[104:119]
    ds_read_b128 v[192:195], v6 offset:22528
    ds_read_b128 v[196:199], v6 offset:23552
    buffer_load_dwordx4 v5, s[20:23], s51 offen offset:1024 sc1 lds
    v_exp_f32 v142, v142
    v_exp_f32 v143, v143
    v_exp_f32 v144, v144
    v_exp_f32 v145, v145
    v_smfmac_f32_32x32x32_bf16 v[152:167], v[224:227], v[136:143], v18
    v_exp_f32 v146, v146
    v_exp_f32 v147, v147
    v_exp_f32 v148, v148
    v_exp_f32 v149, v149
    v_mfma_f32_32x32x16_bf16 v[120:135], v[176:179], v[96:99], 0
    v_exp_f32 v150, v150
    v_exp_f32 v151, v151
    s_waitcnt vmcnt(9) lgkmcnt(0)
    s_barrier
    ds_read_b128 v[200:203], v6 offset:32768
    ds_read_b128 v[204:207], v6 offset:33792
    v_exp_f32 v104, v104
    v_exp_f32 v105, v105
    v_smfmac_f32_32x32x32_bf16 v[152:167], v[228:231], v[144:151], v18
    v_exp_f32 v106, v106
    v_exp_f32 v107, v107
    v_exp_f32 v108, v108
    v_exp_f32 v109, v109
    v_mfma_f32_32x32x16_bf16 v[120:135], v[180:183], v[100:103], v[120:135]
    ds_read_b128 v[208:211], v6 offset:36864
    ds_read_b128 v[212:215], v6 offset:37888
    v_exp_f32 v110, v110
    v_exp_f32 v111, v111
    v_exp_f32 v112, v112
    s_add_u32 m0, s57, 28672
    s_mov_b32 s59, 114688
    v_exp_f32 v113, v113
    v_smfmac_f32_32x32x32_bf16 v[152:167], v[184:187], v[104:111], v18
    ds_read_b128 v[216:219], v6 offset:34816
    ds_read_b128 v[220:223], v6 offset:35840
    buffer_load_dwordx4 v78, s[16:19], s59 offen lds
    v_exp_f32 v114, v114
    v_exp_f32 v115, v115
    v_exp_f32 v116, v116
    v_exp_f32 v117, v117
    s_waitcnt lgkmcnt(2)
    v_mfma_f32_32x32x16_bf16 v[136:151], v[200:203], v[96:99], 0
    v_exp_f32 v118, v118
    v_exp_f32 v119, v119
    v_exp_f32 v120, v120
    s_add_u32 m0, s56, 16384
    s_xor_b32 s51, s58, 163840
    v_exp_f32 v121, v121
    v_smfmac_f32_32x32x32_bf16 v[152:167], v[188:191], v[112:119], v18
    buffer_load_dwordx4 v5, s[20:23], s51 offen offset:0 sc1 lds
    v_exp_f32 v122, v122
    v_exp_f32 v123, v123
    v_exp_f32 v124, v124
    v_exp_f32 v125, v125
    v_mfma_f32_32x32x16_bf16 v[136:151], v[204:207], v[100:103], v[136:151]
    ds_read_b128 v[224:227], v6 offset:38912
    ds_read_b128 v[228:231], v6 offset:39936
    buffer_load_dwordx4 v5, s[20:23], s51 offen offset:1024 sc1 lds
    v_exp_f32 v126, v126
    v_exp_f32 v127, v127
    v_exp_f32 v128, v128
    v_exp_f32 v129, v129
    v_smfmac_f32_32x32x32_bf16 v[152:167], v[192:195], v[120:127], v18
    v_exp_f32 v130, v130
    v_exp_f32 v131, v131
    v_exp_f32 v132, v132
    v_exp_f32 v133, v133
    v_mfma_f32_32x32x16_bf16 v[104:119], v[208:211], v[96:99], 0
    v_exp_f32 v134, v134
    v_exp_f32 v135, v135
    s_waitcnt vmcnt(6) lgkmcnt(0)
    s_barrier
    ds_read_b128 v[168:171], v6 offset:49152
    ds_read_b128 v[172:175], v6 offset:50176
    v_exp_f32 v136, v136
    v_exp_f32 v137, v137
    v_smfmac_f32_32x32x32_bf16 v[152:167], v[196:199], v[128:135], v18
    v_exp_f32 v138, v138
    v_exp_f32 v139, v139
    v_exp_f32 v140, v140
    v_exp_f32 v141, v141
    v_mfma_f32_32x32x16_bf16 v[104:119], v[212:215], v[100:103], v[104:119]
    ds_read_b128 v[176:179], v6 offset:53248
    ds_read_b128 v[180:183], v6 offset:54272
    v_exp_f32 v142, v142
    v_exp_f32 v143, v143
    v_exp_f32 v144, v144
    s_add_u32 m0, s57, 35840
    s_mov_b32 s59, 143360
    v_exp_f32 v145, v145
    v_smfmac_f32_32x32x32_bf16 v[152:167], v[216:219], v[136:143], v18
    ds_read_b128 v[184:187], v6 offset:51200
    ds_read_b128 v[188:191], v6 offset:52224
    buffer_load_dwordx4 v78, s[16:19], s59 offen lds
    v_exp_f32 v146, v146
    v_exp_f32 v147, v147
    v_exp_f32 v148, v148
    v_exp_f32 v149, v149
    s_waitcnt lgkmcnt(2)
    v_mfma_f32_32x32x16_bf16 v[120:135], v[168:171], v[96:99], 0
    v_exp_f32 v150, v150
    v_exp_f32 v151, v151
    v_exp_f32 v104, v104
    s_add_u32 m0, s56, 32768
    s_xor_b32 s51, s58, 180224
    v_exp_f32 v105, v105
    v_smfmac_f32_32x32x32_bf16 v[152:167], v[220:223], v[144:151], v18
    buffer_load_dwordx4 v5, s[20:23], s51 offen offset:0 sc1 lds
    v_exp_f32 v106, v106
    v_exp_f32 v107, v107
    v_exp_f32 v108, v108
    v_exp_f32 v109, v109
    v_mfma_f32_32x32x16_bf16 v[120:135], v[172:175], v[100:103], v[120:135]
    ds_read_b128 v[192:195], v6 offset:55296
    ds_read_b128 v[196:199], v6 offset:56320
    buffer_load_dwordx4 v5, s[20:23], s51 offen offset:1024 sc1 lds
    v_exp_f32 v110, v110
    v_exp_f32 v111, v111
    v_exp_f32 v112, v112
    s_add_u32 m0, s57, 43008
    s_mov_b32 s59, 172032
    v_exp_f32 v113, v113
    v_smfmac_f32_32x32x32_bf16 v[152:167], v[224:227], v[104:111], v18
    buffer_load_dwordx4 v78, s[16:19], s59 offen lds
    v_exp_f32 v114, v114
    v_exp_f32 v115, v115
    v_exp_f32 v116, v116
    v_exp_f32 v117, v117
    v_mfma_f32_32x32x16_bf16 v[136:151], v[176:179], v[96:99], 0
    v_exp_f32 v118, v118
    v_exp_f32 v119, v119
    s_waitcnt vmcnt(7) lgkmcnt(0)
    s_barrier
    ds_read_b128 v[200:203], v6 offset:0
    ds_read_b128 v[204:207], v6 offset:1024
    v_exp_f32 v120, v120
    v_exp_f32 v121, v121
    v_smfmac_f32_32x32x32_bf16 v[152:167], v[228:231], v[112:119], v18
    v_exp_f32 v122, v122
    v_exp_f32 v123, v123
    v_exp_f32 v124, v124
    v_exp_f32 v125, v125
    v_mfma_f32_32x32x16_bf16 v[136:151], v[180:183], v[100:103], v[136:151]
    ds_read_b128 v[208:211], v6 offset:4096
    ds_read_b128 v[212:215], v6 offset:5120
    v_exp_f32 v126, v126
    v_exp_f32 v127, v127
    v_exp_f32 v128, v128
    s_add_u32 m0, s57, 50176
    s_mov_b32 s59, 200704
    v_exp_f32 v129, v129
    v_smfmac_f32_32x32x32_bf16 v[152:167], v[184:187], v[120:127], v18
    ds_read_b128 v[216:219], v6 offset:2048
    ds_read_b128 v[220:223], v6 offset:3072
    buffer_load_dwordx4 v78, s[16:19], s59 offen lds
    v_exp_f32 v130, v130
    v_exp_f32 v131, v131
    v_exp_f32 v132, v132
    v_exp_f32 v133, v133
    s_waitcnt lgkmcnt(2)
    v_mfma_f32_32x32x16_bf16 v[104:119], v[200:203], v[96:99], 0
    v_exp_f32 v134, v134
    v_exp_f32 v135, v135
    v_exp_f32 v136, v136
    s_add_u32 m0, s56, 49152
    s_xor_b32 s51, s58, 196608
    v_exp_f32 v137, v137
    v_smfmac_f32_32x32x32_bf16 v[152:167], v[188:191], v[128:135], v18
    buffer_load_dwordx4 v5, s[20:23], s51 offen offset:0 sc1 lds
    v_exp_f32 v138, v138
    v_exp_f32 v139, v139
    v_exp_f32 v140, v140
    v_exp_f32 v141, v141
    v_mfma_f32_32x32x16_bf16 v[104:119], v[204:207], v[100:103], v[104:119]
    ds_read_b128 v[224:227], v6 offset:6144
    ds_read_b128 v[228:231], v6 offset:7168
    buffer_load_dwordx4 v5, s[20:23], s51 offen offset:1024 sc1 lds
    v_exp_f32 v142, v142
    v_exp_f32 v143, v143
    v_exp_f32 v144, v144
    v_exp_f32 v145, v145
    v_smfmac_f32_32x32x32_bf16 v[152:167], v[192:195], v[136:143], v18
    v_exp_f32 v146, v146
    v_exp_f32 v147, v147
    v_exp_f32 v148, v148
    v_exp_f32 v149, v149
    v_mfma_f32_32x32x16_bf16 v[120:135], v[208:211], v[96:99], 0
    v_exp_f32 v150, v150
    v_exp_f32 v151, v151
    s_waitcnt vmcnt(7) lgkmcnt(0)
    s_barrier
    ds_read_b128 v[168:171], v6 offset:16384
    ds_read_b128 v[172:175], v6 offset:17408
    v_exp_f32 v104, v104
    v_exp_f32 v105, v105
    v_smfmac_f32_32x32x32_bf16 v[152:167], v[196:199], v[144:151], v18
    v_exp_f32 v106, v106
    v_exp_f32 v107, v107
    v_exp_f32 v108, v108
    v_exp_f32 v109, v109
    v_mfma_f32_32x32x16_bf16 v[120:135], v[212:215], v[100:103], v[120:135]
    ds_read_b128 v[176:179], v6 offset:20480
    ds_read_b128 v[180:183], v6 offset:21504
    v_exp_f32 v110, v110
    v_exp_f32 v111, v111
    v_exp_f32 v112, v112
    s_add_u32 m0, s57, 57344
    s_mov_b32 s59, 229376
    v_exp_f32 v113, v113
    v_smfmac_f32_32x32x32_bf16 v[152:167], v[216:219], v[104:111], v18
    ds_read_b128 v[184:187], v6 offset:18432
    ds_read_b128 v[188:191], v6 offset:19456
    buffer_load_dwordx4 v78, s[16:19], s59 offen lds
    v_exp_f32 v114, v114
    v_exp_f32 v115, v115
    v_exp_f32 v116, v116
    v_exp_f32 v117, v117
    s_waitcnt lgkmcnt(2)
    v_mfma_f32_32x32x16_bf16 v[136:151], v[168:171], v[96:99], 0
    v_exp_f32 v118, v118
    v_exp_f32 v119, v119
    v_exp_f32 v120, v120
    s_mov_b32 m0, s56
    s_xor_b32 s51, s58, 212992
    v_exp_f32 v121, v121
    v_smfmac_f32_32x32x32_bf16 v[152:167], v[220:223], v[112:119], v18
    buffer_load_dwordx4 v5, s[20:23], s51 offen offset:0 sc1 lds
    v_exp_f32 v122, v122
    v_exp_f32 v123, v123
    v_exp_f32 v124, v124
    v_exp_f32 v125, v125
    v_mfma_f32_32x32x16_bf16 v[136:151], v[172:175], v[100:103], v[136:151]
    ds_read_b128 v[192:195], v6 offset:22528
    ds_read_b128 v[196:199], v6 offset:23552
    buffer_load_dwordx4 v5, s[20:23], s51 offen offset:1024 sc1 lds
    v_exp_f32 v126, v126
    v_exp_f32 v127, v127
    v_exp_f32 v128, v128
    v_exp_f32 v129, v129
    v_smfmac_f32_32x32x32_bf16 v[152:167], v[224:227], v[120:127], v18
    v_exp_f32 v130, v130
    v_exp_f32 v131, v131
    v_exp_f32 v132, v132
    v_exp_f32 v133, v133
    v_mfma_f32_32x32x16_bf16 v[104:119], v[176:179], v[96:99], 0
    v_exp_f32 v134, v134
    v_exp_f32 v135, v135
    s_waitcnt vmcnt(7) lgkmcnt(0)
    s_barrier
    ds_read_b128 v[200:203], v6 offset:32768
    ds_read_b128 v[204:207], v6 offset:33792
    v_exp_f32 v136, v136
    v_exp_f32 v137, v137
    v_smfmac_f32_32x32x32_bf16 v[152:167], v[228:231], v[128:135], v18
    v_exp_f32 v138, v138
    v_exp_f32 v139, v139
    v_exp_f32 v140, v140
    v_exp_f32 v141, v141
    v_mfma_f32_32x32x16_bf16 v[104:119], v[180:183], v[100:103], v[104:119]
    ds_read_b128 v[208:211], v6 offset:36864
    ds_read_b128 v[212:215], v6 offset:37888
    v_exp_f32 v142, v142
    v_exp_f32 v143, v143
    v_exp_f32 v144, v144
    s_add_u32 m0, s57, 64512
    s_mov_b32 s59, 258048
    v_exp_f32 v145, v145
    v_smfmac_f32_32x32x32_bf16 v[152:167], v[184:187], v[136:143], v18
    ds_read_b128 v[216:219], v6 offset:34816
    ds_read_b128 v[220:223], v6 offset:35840
    buffer_load_dwordx4 v78, s[16:19], s59 offen lds
    v_exp_f32 v146, v146
    v_exp_f32 v147, v147
    v_exp_f32 v148, v148
    v_exp_f32 v149, v149
    s_waitcnt lgkmcnt(2)
    v_mfma_f32_32x32x16_bf16 v[120:135], v[200:203], v[96:99], 0
    v_exp_f32 v150, v150
    v_exp_f32 v151, v151
    v_exp_f32 v104, v104
    s_add_u32 m0, s56, 16384
    s_xor_b32 s51, s58, 229376
    v_exp_f32 v105, v105
    v_smfmac_f32_32x32x32_bf16 v[152:167], v[188:191], v[144:151], v18
    buffer_load_dwordx4 v5, s[20:23], s51 offen offset:0 sc1 lds
    v_exp_f32 v106, v106
    v_exp_f32 v107, v107
    v_exp_f32 v108, v108
    v_exp_f32 v109, v109
    v_mfma_f32_32x32x16_bf16 v[120:135], v[204:207], v[100:103], v[120:135]
    ds_read_b128 v[224:227], v6 offset:38912
    ds_read_b128 v[228:231], v6 offset:39936
    buffer_load_dwordx4 v5, s[20:23], s51 offen offset:1024 sc1 lds
    v_exp_f32 v110, v110
    v_exp_f32 v111, v111
    v_exp_f32 v112, v112
    v_exp_f32 v113, v113
    v_smfmac_f32_32x32x32_bf16 v[152:167], v[192:195], v[104:111], v18
    s_mul_i32 s52, s47, 28672
    buffer_load_dwordx4 v[52:55], v7, s[4:7], s52 offen
    v_exp_f32 v114, v114
    v_exp_f32 v115, v115
    v_exp_f32 v116, v116
    v_exp_f32 v117, v117
    v_mfma_f32_32x32x16_bf16 v[136:151], v[208:211], v[96:99], 0
    v_exp_f32 v118, v118
    v_exp_f32 v119, v119
    s_waitcnt vmcnt(7) lgkmcnt(0)
    s_barrier
    ds_read_b128 v[168:171], v6 offset:49152
    ds_read_b128 v[172:175], v6 offset:50176
    v_exp_f32 v120, v120
    v_exp_f32 v121, v121
    v_smfmac_f32_32x32x32_bf16 v[152:167], v[196:199], v[112:119], v18
    v_exp_f32 v122, v122
    v_exp_f32 v123, v123
    v_exp_f32 v124, v124
    v_exp_f32 v125, v125
    v_mfma_f32_32x32x16_bf16 v[136:151], v[212:215], v[100:103], v[136:151]
    ds_read_b128 v[176:179], v6 offset:53248
    ds_read_b128 v[180:183], v6 offset:54272
    v_exp_f32 v126, v126
    v_exp_f32 v127, v127
    v_exp_f32 v128, v128
    s_add_u32 m0, s57, 71680
    s_mov_b32 s59, 286720
    v_exp_f32 v129, v129
    v_smfmac_f32_32x32x32_bf16 v[152:167], v[216:219], v[120:127], v18
    ds_read_b128 v[184:187], v6 offset:51200
    ds_read_b128 v[188:191], v6 offset:52224
    buffer_load_dwordx4 v78, s[16:19], s59 offen lds
    v_exp_f32 v130, v130
    v_exp_f32 v131, v131
    v_exp_f32 v132, v132
    v_exp_f32 v133, v133
    s_waitcnt lgkmcnt(2)
    v_mfma_f32_32x32x16_bf16 v[104:119], v[168:171], v[96:99], 0
    v_exp_f32 v134, v134
    v_exp_f32 v135, v135
    v_exp_f32 v136, v136
    s_add_u32 m0, s56, 32768
    s_xor_b32 s51, s58, 245760
    v_exp_f32 v137, v137
    v_smfmac_f32_32x32x32_bf16 v[152:167], v[220:223], v[128:135], v18
    buffer_load_dwordx4 v5, s[20:23], s51 offen offset:0 sc1 lds
    v_exp_f32 v138, v138
    v_exp_f32 v139, v139
    v_exp_f32 v140, v140
    v_exp_f32 v141, v141
    v_mfma_f32_32x32x16_bf16 v[104:119], v[172:175], v[100:103], v[104:119]
    ds_read_b128 v[192:195], v6 offset:55296
    ds_read_b128 v[196:199], v6 offset:56320
    buffer_load_dwordx4 v5, s[20:23], s51 offen offset:1024 sc1 lds
    v_exp_f32 v142, v142
    v_exp_f32 v143, v143
    v_exp_f32 v144, v144
    s_add_u32 m0, s57, 78848
    s_mov_b32 s59, 315392
    v_exp_f32 v145, v145
    v_smfmac_f32_32x32x32_bf16 v[152:167], v[224:227], v[136:143], v18
    buffer_load_dwordx4 v78, s[16:19], s59 offen lds
    v_exp_f32 v146, v146
    v_exp_f32 v147, v147
    v_exp_f32 v148, v148
    v_exp_f32 v149, v149
    v_mfma_f32_32x32x16_bf16 v[120:135], v[176:179], v[96:99], 0
    buffer_load_dwordx2 v[56:57], v17, s[32:35], 0 offen
    buffer_load_dwordx4 v[60:63], v2, s[32:35], 0 offen
    v_exp_f32 v150, v150
    v_exp_f32 v151, v151
    s_waitcnt vmcnt(10) lgkmcnt(0)
    s_barrier
    ds_read_b128 v[200:203], v6 offset:0
    ds_read_b128 v[204:207], v6 offset:1024
    v_exp_f32 v104, v104
    v_exp_f32 v105, v105
    v_smfmac_f32_32x32x32_bf16 v[152:167], v[228:231], v[144:151], v18
    v_exp_f32 v106, v106
    v_exp_f32 v107, v107
    v_exp_f32 v108, v108
    v_exp_f32 v109, v109
    v_mfma_f32_32x32x16_bf16 v[120:135], v[180:183], v[100:103], v[120:135]
    ds_read_b128 v[208:211], v6 offset:4096
    ds_read_b128 v[212:215], v6 offset:5120
    v_exp_f32 v110, v110
    v_exp_f32 v111, v111
    v_exp_f32 v112, v112
    s_add_u32 m0, s57, 86016
    s_mov_b32 s59, 344064
    v_exp_f32 v113, v113
    v_smfmac_f32_32x32x32_bf16 v[152:167], v[184:187], v[104:111], v18
    ds_read_b128 v[216:219], v6 offset:2048
    ds_read_b128 v[220:223], v6 offset:3072
    buffer_load_dwordx4 v78, s[16:19], s59 offen lds
    v_exp_f32 v114, v114
    v_exp_f32 v115, v115
    v_exp_f32 v116, v116
    v_exp_f32 v117, v117
    s_waitcnt lgkmcnt(2)
    v_mfma_f32_32x32x16_bf16 v[136:151], v[200:203], v[96:99], 0
    v_exp_f32 v118, v118
    v_exp_f32 v119, v119
    v_exp_f32 v120, v120
    v_exp_f32 v121, v121
    v_smfmac_f32_32x32x32_bf16 v[152:167], v[188:191], v[112:119], v18
    v_exp_f32 v122, v122
    v_exp_f32 v123, v123
    v_exp_f32 v124, v124
    v_exp_f32 v125, v125
    v_mfma_f32_32x32x16_bf16 v[136:151], v[204:207], v[100:103], v[136:151]
    ds_read_b128 v[224:227], v6 offset:6144
    ds_read_b128 v[228:231], v6 offset:7168
    v_exp_f32 v126, v126
    v_exp_f32 v127, v127
    v_exp_f32 v128, v128
    v_exp_f32 v129, v129
    v_smfmac_f32_32x32x32_bf16 v[152:167], v[192:195], v[120:127], v18
    s_mov_b32 s52, 8388612
    buffer_load_dword v70, v16, s[20:23], s52 offen sc1
    v_exp_f32 v130, v130
    v_exp_f32 v131, v131
    v_exp_f32 v132, v132
    v_exp_f32 v133, v133
    v_mfma_f32_32x32x16_bf16 v[104:119], v[208:211], v[96:99], 0
    v_exp_f32 v134, v134
    v_exp_f32 v135, v135
    s_waitcnt vmcnt(9) lgkmcnt(0)
    s_barrier
    ds_read_b128 v[168:171], v6 offset:16384
    ds_read_b128 v[172:175], v6 offset:17408
    v_exp_f32 v136, v136
    v_exp_f32 v137, v137
    v_smfmac_f32_32x32x32_bf16 v[152:167], v[196:199], v[128:135], v18
    v_exp_f32 v138, v138
    v_exp_f32 v139, v139
    v_exp_f32 v140, v140
    v_exp_f32 v141, v141
    v_mfma_f32_32x32x16_bf16 v[104:119], v[212:215], v[100:103], v[104:119]
    ds_read_b128 v[176:179], v6 offset:20480
    ds_read_b128 v[180:183], v6 offset:21504
    v_exp_f32 v142, v142
    v_exp_f32 v143, v143
    v_exp_f32 v144, v144
    s_add_u32 m0, s57, 93184
    s_mov_b32 s59, 372736
    v_exp_f32 v145, v145
    v_smfmac_f32_32x32x32_bf16 v[152:167], v[216:219], v[136:143], v18
    ds_read_b128 v[184:187], v6 offset:18432
    ds_read_b128 v[188:191], v6 offset:19456
    buffer_load_dwordx4 v78, s[16:19], s59 offen lds
    v_exp_f32 v146, v146
    v_exp_f32 v147, v147
    v_exp_f32 v148, v148
    v_exp_f32 v149, v149
    s_waitcnt lgkmcnt(2)
    v_mfma_f32_32x32x16_bf16 v[120:135], v[168:171], v[96:99], 0
    v_exp_f32 v150, v150
    v_exp_f32 v151, v151
    v_exp_f32 v104, v104
    v_exp_f32 v105, v105
    v_smfmac_f32_32x32x32_bf16 v[152:167], v[220:223], v[144:151], v18
    v_exp_f32 v106, v106
    v_exp_f32 v107, v107
    v_exp_f32 v108, v108
    v_exp_f32 v109, v109
    v_mfma_f32_32x32x16_bf16 v[120:135], v[172:175], v[100:103], v[120:135]
    ds_read_b128 v[192:195], v6 offset:22528
    ds_read_b128 v[196:199], v6 offset:23552
    v_exp_f32 v110, v110
    v_exp_f32 v111, v111
    v_exp_f32 v112, v112
    v_exp_f32 v113, v113
    v_smfmac_f32_32x32x32_bf16 v[152:167], v[224:227], v[104:111], v18
    v_exp_f32 v114, v114
    v_exp_f32 v115, v115
    v_exp_f32 v116, v116
    v_exp_f32 v117, v117
    v_mfma_f32_32x32x16_bf16 v[136:151], v[176:179], v[96:99], 0
    v_exp_f32 v118, v118
    v_exp_f32 v119, v119
    s_waitcnt vmcnt(6) lgkmcnt(0)
    s_barrier
    ds_read_b128 v[200:203], v6 offset:32768
    ds_read_b128 v[204:207], v6 offset:33792
    v_exp_f32 v120, v120
    v_exp_f32 v121, v121
    v_smfmac_f32_32x32x32_bf16 v[152:167], v[228:231], v[112:119], v18
    v_exp_f32 v122, v122
    v_exp_f32 v123, v123
    v_exp_f32 v124, v124
    v_exp_f32 v125, v125
    v_mfma_f32_32x32x16_bf16 v[136:151], v[180:183], v[100:103], v[136:151]
    ds_read_b128 v[208:211], v6 offset:36864
    ds_read_b128 v[212:215], v6 offset:37888
    v_exp_f32 v126, v126
    v_exp_f32 v127, v127
    v_exp_f32 v128, v128
    s_mov_b32 m0, s57
    s_mov_b32 s59, 0
    v_exp_f32 v129, v129
    v_smfmac_f32_32x32x32_bf16 v[152:167], v[184:187], v[120:127], v18
    ds_read_b128 v[216:219], v6 offset:34816
    ds_read_b128 v[220:223], v6 offset:35840
    buffer_load_dwordx4 v78, s[16:19], s59 offen lds
    v_exp_f32 v130, v130
    v_exp_f32 v131, v131
    v_exp_f32 v132, v132
    v_exp_f32 v133, v133
    s_waitcnt lgkmcnt(2)
    v_mfma_f32_32x32x16_bf16 v[104:119], v[200:203], v[96:99], 0
    v_exp_f32 v134, v134
    v_exp_f32 v135, v135
    v_exp_f32 v136, v136
    v_exp_f32 v137, v137
    v_smfmac_f32_32x32x32_bf16 v[152:167], v[188:191], v[128:135], v18
    v_exp_f32 v138, v138
    v_exp_f32 v139, v139
    v_exp_f32 v140, v140
    v_exp_f32 v141, v141
    v_mfma_f32_32x32x16_bf16 v[104:119], v[204:207], v[100:103], v[104:119]
    ds_read_b128 v[224:227], v6 offset:38912
    ds_read_b128 v[228:231], v6 offset:39936
    v_exp_f32 v142, v142
    v_exp_f32 v143, v143
    v_exp_f32 v144, v144
    v_exp_f32 v145, v145
    v_smfmac_f32_32x32x32_bf16 v[152:167], v[192:195], v[136:143], v18
    v_exp_f32 v146, v146
    v_exp_f32 v147, v147
    v_exp_f32 v148, v148
    v_exp_f32 v149, v149
    v_mfma_f32_32x32x16_bf16 v[120:135], v[208:211], v[96:99], 0
    v_exp_f32 v150, v150
    v_exp_f32 v151, v151
    s_waitcnt lgkmcnt(0)
    s_barrier
    v_exp_f32 v104, v104
    v_exp_f32 v105, v105
    v_smfmac_f32_32x32x32_bf16 v[152:167], v[196:199], v[144:151], v18
    v_exp_f32 v106, v106
    v_exp_f32 v107, v107
    v_exp_f32 v108, v108
    v_exp_f32 v109, v109
    v_mfma_f32_32x32x16_bf16 v[120:135], v[212:215], v[100:103], v[120:135]
    v_exp_f32 v110, v110
    v_exp_f32 v111, v111
    v_exp_f32 v112, v112
    v_exp_f32 v113, v113
    v_smfmac_f32_32x32x32_bf16 v[152:167], v[216:219], v[104:111], v18
    s_waitcnt vmcnt(2)
    v_cmp_gt_u32 vcc, 16, v70
    s_and_b32 vcc_lo, vcc_lo, 0xffff
    s_cbranch_scc1 L_17
L_18:
    v_exp_f32 v114, v114
    v_exp_f32 v115, v115
    v_exp_f32 v116, v116
    v_exp_f32 v117, v117
    v_exp_f32 v118, v118
    v_exp_f32 v119, v119
    v_exp_f32 v120, v120
    v_exp_f32 v121, v121
    v_smfmac_f32_32x32x32_bf16 v[152:167], v[220:223], v[112:119], v18
    v_exp_f32 v122, v122
    v_exp_f32 v123, v123
    v_exp_f32 v124, v124
    v_exp_f32 v125, v125
    v_exp_f32 v126, v126
    v_exp_f32 v127, v127
    v_exp_f32 v128, v128
    v_exp_f32 v129, v129
    v_smfmac_f32_32x32x32_bf16 v[152:167], v[224:227], v[120:127], v18
    v_exp_f32 v130, v130
    v_exp_f32 v131, v131
    v_exp_f32 v132, v132
    v_exp_f32 v133, v133
    v_exp_f32 v134, v134
    v_exp_f32 v135, v135
L_tail0:
    s_nop 1
    v_smfmac_f32_32x32x32_bf16 v[152:167], v[228:231], v[128:135], v18
    v_mov_b32 v14, 160804
    v_mov_b32 v15, 1
    s_mov_b32 s53, 0x71800000
    v_mov_b32 v21, v19
    s_cmp_eq_u32 s63, 0
    s_cselect_b32 s52, s72, 0x40000000
    s_mov_b64 exec, 1
    buffer_atomic_add v15, v2, s[20:23], s52 offen sc1
    s_mov_b64 exec, -1
    s_nop 1
    s_nop 0
    v_mov_b32 v20, v164
    v_mov_b32 v13, v164
    ds_write_b128 v59, v[160:163]
    ds_write_b128 v59, v[164:167] offset:1024
    v_permlane32_swap_b32 v13, v20
    v_pk_add_f32 v[22:23], v[152:153], v[154:155]
    v_pk_add_f32 v[10:11], v[156:157], v[158:159]
    ds_write_b64 v59, v[20:21] offset:2048
    v_pk_add_f32 v[22:23], v[22:23], v[160:161]
    v_pk_add_f32 v[10:11], v[10:11], v[162:163]
    v_pk_add_f32 v[22:23], v[22:23], v[164:165]
    v_pk_add_f32 v[10:11], v[10:11], v[166:167]
    v_pk_add_f32 v[22:23], v[22:23], v[10:11]
    v_add_f32 v22, v22, v23
    v_add_f32 v22, abs(v22), v20
    v_cmp_ngt_f32 vcc, s53, v22
    s_mov_b64 exec, vcc
    ds_or_b32 v14, v15
    s_mov_b64 exec, -1
    s_waitcnt vmcnt(0) lgkmcnt(0)
    s_barrier
    ds_read_b64 v[22:23], v69 offset:2048
    ds_read_b32 v15, v14
    ds_read_b128 v[160:163], v69
    ds_read_b128 v[164:167], v69 offset:1024
    s_waitcnt lgkmcnt(3)
    v_max_f32 v10, v21, v23
    v_sub_f32 v21, v21, v10
    v_sub_f32 v23, v23, v10
    v_exp_f32 v21, v21
    v_exp_f32 v23, v23
    s_waitcnt lgkmcnt(2)
    v_readfirstlane_b32 s52, v15
    v_mul_f32 v20, v20, v21
    v_fmac_f32 v20, v22, v23
    s_cmp_gt_u32 s52, s63
    s_cbranch_scc1 L_fallback
    v_rcp_f32 v20, v20
    s_waitcnt lgkmcnt(0)
    v_mul_f32 v10, v21, v20
    v_mul_f32 v12, v23, v20
    v_pk_mul_f32 v[152:153], v[152:153], v[10:11] op_sel_hi:[1,0]
    v_pk_mul_f32 v[154:155], v[154:155], v[10:11] op_sel_hi:[1,0]
    v_pk_mul_f32 v[156:157], v[156:157], v[10:11] op_sel_hi:[1,0]
    v_pk_mul_f32 v[158:159], v[158:159], v[10:11] op_sel_hi:[1,0]
    v_pk_fma_f32 v[152:153], v[160:161], v[12:13], v[152:153] op_sel_hi:[1,0,1]
    v_pk_fma_f32 v[154:155], v[162:163], v[12:13], v[154:155] op_sel_hi:[1,0,1]
    v_pk_fma_f32 v[156:157], v[164:165], v[12:13], v[156:157] op_sel_hi:[1,0,1]
    v_pk_fma_f32 v[158:159], v[166:167], v[12:13], v[158:159] op_sel_hi:[1,0,1]
    v_cvt_pk_bf16_f32 v232, v152, v153
    v_cvt_pk_bf16_f32 v233, v154, v155
    v_cvt_pk_bf16_f32 v234, v156, v157
    v_cvt_pk_bf16_f32 v235, v158, v159
    buffer_store_dwordx4 v[232:235], v2, s[20:23], s60 offen sc1
    s_branch L_loopd
L_loopf:
    s_cmp_eq_u32 s42, 1
    s_cbranch_scc1 L_loopf1
    s_waitcnt vmcnt(4) lgkmcnt(0)
    s_barrier
    ds_read_b128 v[200:203], v6 offset:0
    ds_read_b128 v[204:207], v6 offset:1024
    v_exp_f32 v104, v104
    v_exp_f32 v105, v105
    v_exp_f32 v106, v106
    v_exp_f32 v107, v107
    v_exp_f32 v108, v108
    v_exp_f32 v109, v109
    v_mfma_f32_32x32x16_bf16 v[120:135], v[180:183], v[100:103], v[120:135]
    ds_read_b128 v[208:211], v6 offset:4096
    ds_read_b128 v[212:215], v6 offset:5120
    v_exp_f32 v110, v110
    v_exp_f32 v111, v111
    v_exp_f32 v112, v112
    v_exp_f32 v113, v113
    v_smfmac_f32_32x32x32_bf16 v[152:167], v[184:187], v[104:111], v18
    ds_read_b128 v[216:219], v6 offset:2048
    ds_read_b128 v[220:223], v6 offset:3072
    v_exp_f32 v114, v114
    v_exp_f32 v115, v115
    v_exp_f32 v116, v116
    v_exp_f32 v117, v117
    s_waitcnt lgkmcnt(2)
    v_mfma_f32_32x32x16_bf16 v[136:151], v[200:203], v[96:99], 0
    v_exp_f32 v118, v118
    v_exp_f32 v119, v119
    v_exp_f32 v120, v120
    s_add_u32 m0, s56, 49152
    s_xor_b32 s51, s58, 65536
    v_exp_f32 v121, v121
    v_smfmac_f32_32x32x32_bf16 v[152:167], v[188:191], v[112:119], v18
    buffer_load_dwordx4 v5, s[20:23], s51 offen offset:0 sc1 lds
    v_exp_f32 v122, v122
    v_exp_f32 v123, v123
    v_exp_f32 v124, v124
    v_exp_f32 v125, v125
    v_mfma_f32_32x32x16_bf16 v[136:151], v[204:207], v[100:103], v[136:151]
    ds_read_b128 v[224:227], v6 offset:6144
    ds_read_b128 v[228:231], v6 offset:7168
    buffer_load_dwordx4 v5, s[20:23], s51 offen offset:1024 sc1 lds
    v_exp_f32 v126, v126
    v_exp_f32 v127, v127
    v_exp_f32 v128, v128
    v_exp_f32 v129, v129
    v_smfmac_f32_32x32x32_bf16 v[152:167], v[192:195], v[120:127], v18
    v_exp_f32 v130, v130
    v_exp_f32 v131, v131
    v_exp_f32 v132, v132
    v_exp_f32 v133, v133
    v_mfma_f32_32x32x16_bf16 v[104:119], v[208:211], v[96:99], 0
    v_exp_f32 v134, v134
    v_exp_f32 v135, v135
    s_waitcnt vmcnt(4) lgkmcnt(0)
    s_barrier
    ds_read_b128 v[168:171], v6 offset:16384
    ds_read_b128 v[172:175], v6 offset:17408
    v_exp_f32 v136, v136
    v_exp_f32 v137, v137
    v_smfmac_f32_32x32x32_bf16 v[152:167], v[196:199], v[128:135], v18
    v_exp_f32 v138, v138
    v_exp_f32 v139, v139
    v_exp_f32 v140, v140
    v_exp_f32 v141, v141
    v_mfma_f32_32x32x16_bf16 v[104:119], v[212:215], v[100:103], v[104:119]
    ds_read_b128 v[176:179], v6 offset:20480
    ds_read_b128 v[180:183], v6 offset:21504
    v_exp_f32 v142, v142
    v_exp_f32 v143, v143
    v_exp_f32 v144, v144
    v_exp_f32 v145, v145
    v_smfmac_f32_32x32x32_bf16 v[152:167], v[216:219], v[136:143], v18
    ds_read_b128 v[184:187], v6 offset:18432
    ds_read_b128 v[188:191], v6 offset:19456
    s_add_u32 s52, s40, s63
    s_cmp_lg_u32 s52, 0
    s_cbranch_scc1 L_19
    s_lshl_b32 s52, s43, 10
    s_add_u32 s52, s52, 8388612
    s_mov_b64 exec, 1
    v_mov_b32 v10, 1
    buffer_atomic_add v10, v2, s[20:23], s52 offen sc1
    s_mov_b64 exec, -1
L_19:
    v_exp_f32 v146, v146
    v_exp_f32 v147, v147
    v_exp_f32 v148, v148
    v_exp_f32 v149, v149
    s_waitcnt lgkmcnt(2)
    v_mfma_f32_32x32x16_bf16 v[120:135], v[168:171], v[96:99], 0
    v_exp_f32 v150, v150
    v_exp_f32 v151, v151
    v_exp_f32 v104, v104
    s_mov_b32 m0, s56
    s_xor_b32 s51, s58, 81920
    v_exp_f32 v105, v105
    v_smfmac_f32_32x32x32_bf16 v[152:167], v[220:223], v[144:151], v18
    buffer_load_dwordx4 v5, s[20:23], s51 offen offset:0 sc1 lds
    v_exp_f32 v106, v106
    v_exp_f32 v107, v107
    v_exp_f32 v108, v108
    v_exp_f32 v109, v109
    v_mfma_f32_32x32x16_bf16 v[120:135], v[172:175], v[100:103], v[120:135]
    ds_read_b128 v[192:195], v6 offset:22528
    ds_read_b128 v[196:199], v6 offset:23552
    buffer_load_dwordx4 v5, s[20:23], s51 offen offset:1024 sc1 lds
    v_exp_f32 v110, v110
    v_exp_f32 v111, v111
    v_exp_f32 v112, v112
    v_exp_f32 v113, v113
    v_smfmac_f32_32x32x32_bf16 v[152:167], v[224:227], v[104:111], v18
    v_exp_f32 v114, v114
    v_exp_f32 v115, v115
    v_exp_f32 v116, v116
    v_exp_f32 v117, v117
    v_mfma_f32_32x32x16_bf16 v[136:151], v[176:179], v[96:99], 0
    v_exp_f32 v118, v118
    v_exp_f32 v119, v119
    s_waitcnt vmcnt(4) lgkmcnt(0)
    s_barrier
    ds_read_b128 v[200:203], v6 offset:32768
    ds_read_b128 v[204:207], v6 offset:33792
    v_exp_f32 v120, v120
    v_exp_f32 v121, v121
    v_smfmac_f32_32x32x32_bf16 v[152:167], v[228:231], v[112:119], v18
    v_exp_f32 v122, v122
    v_exp_f32 v123, v123
    v_exp_f32 v124, v124
    v_exp_f32 v125, v125
    v_mfma_f32_32x32x16_bf16 v[136:151], v[180:183], v[100:103], v[136:151]
    ds_read_b128 v[208:211], v6 offset:36864
    ds_read_b128 v[212:215], v6 offset:37888
    v_exp_f32 v126, v126
    v_exp_f32 v127, v127
    v_exp_f32 v128, v128
    v_exp_f32 v129, v129
    v_smfmac_f32_32x32x32_bf16 v[152:167], v[184:187], v[120:127], v18
    ds_read_b128 v[216:219], v6 offset:34816
    ds_read_b128 v[220:223], v6 offset:35840
    v_exp_f32 v130, v130
    v_exp_f32 v131, v131
    v_exp_f32 v132, v132
    v_exp_f32 v133, v133
    s_waitcnt lgkmcnt(2)
    v_mfma_f32_32x32x16_bf16 v[104:119], v[200:203], v[96:99], 0
    v_exp_f32 v134, v134
    v_exp_f32 v135, v135
    v_exp_f32 v136, v136
    s_add_u32 m0, s56, 16384
    s_xor_b32 s51, s58, 98304
    v_exp_f32 v137, v137
    v_smfmac_f32_32x32x32_bf16 v[152:167], v[188:191], v[128:135], v18
    buffer_load_dwordx4 v5, s[20:23], s51 offen offset:0 sc1 lds
    v_exp_f32 v138, v138
    v_exp_f32 v139, v139
    v_exp_f32 v140, v140
    v_exp_f32 v141, v141
    v_mfma_f32_32x32x16_bf16 v[104:119], v[204:207], v[100:103], v[104:119]
    ds_read_b128 v[224:227], v6 offset:38912
    ds_read_b128 v[228:231], v6 offset:39936
    buffer_load_dwordx4 v5, s[20:23], s51 offen offset:1024 sc1 lds
    v_exp_f32 v142, v142
    v_exp_f32 v143, v143
    v_exp_f32 v144, v144
    v_exp_f32 v145, v145
    v_smfmac_f32_32x32x32_bf16 v[152:167], v[192:195], v[136:143], v18
    v_exp_f32 v146, v146
    v_exp_f32 v147, v147
    v_exp_f32 v148, v148
    v_exp_f32 v149, v149
    v_mfma_f32_32x32x16_bf16 v[120:135], v[208:211], v[96:99], 0
    v_exp_f32 v150, v150
    v_exp_f32 v151, v151
    s_waitcnt vmcnt(4) lgkmcnt(0)
    s_barrier
    ds_read_b128 v[168:171], v6 offset:49152
    ds_read_b128 v[172:175], v6 offset:50176
    v_exp_f32 v104, v104
    v_exp_f32 v105, v105
    v_smfmac_f32_32x32x32_bf16 v[152:167], v[196:199], v[144:151], v18
    v_exp_f32 v106, v106
    v_exp_f32 v107, v107
    v_exp_f32 v108, v108
    v_exp_f32 v109, v109
    v_mfma_f32_32x32x16_bf16 v[120:135], v[212:215], v[100:103], v[120:135]
    ds_read_b128 v[176:179], v6 offset:53248
    ds_read_b128 v[180:183], v6 offset:54272
    v_exp_f32 v110, v110
    v_exp_f32 v111, v111
    v_exp_f32 v112, v112
    v_exp_f32 v113, v113
    v_smfmac_f32_32x32x32_bf16 v[152:167], v[216:219], v[104:111], v18
    ds_read_b128 v[184:187], v6 offset:51200
    ds_read_b128 v[188:191], v6 offset:52224
    v_exp_f32 v114, v114
    v_exp_f32 v115, v115
    v_exp_f32 v116, v116
    v_exp_f32 v117, v117
    s_waitcnt lgkmcnt(2)
    v_mfma_f32_32x32x16_bf16 v[136:151], v[168:171], v[96:99], 0
    v_exp_f32 v118, v118
    v_exp_f32 v119, v119
    v_exp_f32 v120, v120
    s_add_u32 m0, s56, 32768
    s_xor_b32 s51, s58, 114688
    v_exp_f32 v121, v121
    v_smfmac_f32_32x32x32_bf16 v[152:167], v[220:223], v[112:119], v18
    buffer_load_dwordx4 v5, s[20:23], s51 offen offset:0 sc1 lds
    v_exp_f32 v122, v122
    v_exp_f32 v123, v123
    v_exp_f32 v124, v124
    v_exp_f32 v125, v125
    v_mfma_f32_32x32x16_bf16 v[136:151], v[172:175], v[100:103], v[136:151]
    ds_read_b128 v[192:195], v6 offset:55296
    ds_read_b128 v[196:199], v6 offset:56320
    buffer_load_dwordx4 v5, s[20:23], s51 offen offset:1024 sc1 lds
    v_exp_f32 v126, v126
    v_exp_f32 v127, v127
    v_exp_f32 v128, v128
    v_exp_f32 v129, v129
    v_smfmac_f32_32x32x32_bf16 v[152:167], v[224:227], v[120:127], v18
    v_exp_f32 v130, v130
    v_exp_f32 v131, v131
    v_exp_f32 v132, v132
    v_exp_f32 v133, v133
    v_mfma_f32_32x32x16_bf16 v[104:119], v[176:179], v[96:99], 0
    v_exp_f32 v134, v134
    v_exp_f32 v135, v135
    s_waitcnt vmcnt(4) lgkmcnt(0)
    s_barrier
    ds_read_b128 v[200:203], v6 offset:0
    ds_read_b128 v[204:207], v6 offset:1024
    v_exp_f32 v136, v136
    v_exp_f32 v137, v137
    v_smfmac_f32_32x32x32_bf16 v[152:167], v[228:231], v[128:135], v18
    v_exp_f32 v138, v138
    v_exp_f32 v139, v139
    v_exp_f32 v140, v140
    v_exp_f32 v141, v141
    v_mfma_f32_32x32x16_bf16 v[104:119], v[180:183], v[100:103], v[104:119]
    ds_read_b128 v[208:211], v6 offset:4096
    ds_read_b128 v[212:215], v6 offset:5120
    v_exp_f32 v142, v142
    v_exp_f32 v143, v143
    v_exp_f32 v144, v144
    s_add_u32 m0, s57, 7168
    s_mov_b32 s59, 28672
    v_exp_f32 v145, v145
    v_smfmac_f32_32x32x32_bf16 v[152:167], v[184:187], v[136:143], v18
    ds_read_b128 v[216:219], v6 offset:2048
    ds_read_b128 v[220:223], v6 offset:3072
    buffer_load_dwordx4 v78, s[16:19], s59 offen lds
    v_exp_f32 v146, v146
    v_exp_f32 v147, v147
    v_exp_f32 v148, v148
    v_exp_f32 v149, v149
    s_waitcnt lgkmcnt(2)
    v_mfma_f32_32x32x16_bf16 v[120:135], v[200:203], v[96:99], 0
    v_exp_f32 v150, v150
    v_exp_f32 v151, v151
    v_exp_f32 v104, v104
    s_add_u32 m0, s56, 49152
    s_xor_b32 s51, s58, 131072
    v_exp_f32 v105, v105
    v_smfmac_f32_32x32x32_bf16 v[152:167], v[188:191], v[144:151], v18
    buffer_load_dwordx4 v5, s[20:23], s51 offen offset:0 sc1 lds
    v_exp_f32 v106, v106
    v_exp_f32 v107, v107
    v_exp_f32 v108, v108
    v_exp_f32 v109, v109
    v_mfma_f32_32x32x16_bf16 v[120:135], v[204:207], v[100:103], v[120:135]
    ds_read_b128 v[224:227], v6 offset:6144
    ds_read_b128 v[228:231], v6 offset:7168
    buffer_load_dwordx4 v5, s[20:23], s51 offen offset:1024 sc1 lds
    v_exp_f32 v110, v110
    v_exp_f32 v111, v111
    v_exp_f32 v112, v112
    s_add_u32 m0, s57, 14336
    s_mov_b32 s59, 57344
    v_exp_f32 v113, v113
    v_smfmac_f32_32x32x32_bf16 v[152:167], v[192:195], v[104:111], v18
    buffer_load_dwordx4 v78, s[16:19], s59 offen lds
    v_exp_f32 v114, v114
    v_exp_f32 v115, v115
    v_exp_f32 v116, v116
    v_exp_f32 v117, v117
    v_mfma_f32_32x32x16_bf16 v[136:151], v[208:211], v[96:99], 0
    v_exp_f32 v118, v118
    v_exp_f32 v119, v119
    s_waitcnt vmcnt(6) lgkmcnt(0)
    s_barrier
    ds_read_b128 v[168:171], v6 offset:16384
    ds_read_b128 v[172:175], v6 offset:17408
    v_exp_f32 v120, v120
    v_exp_f32 v121, v121
    v_smfmac_f32_32x32x32_bf16 v[152:167], v[196:199], v[112:119], v18
    v_exp_f32 v122, v122
    v_exp_f32 v123, v123
    v_exp_f32 v124, v124
    v_exp_f32 v125, v125
    v_mfma_f32_32x32x16_bf16 v[136:151], v[212:215], v[100:103], v[136:151]
    ds_read_b128 v[176:179], v6 offset:20480
    ds_read_b128 v[180:183], v6 offset:21504
    v_exp_f32 v126, v126
    v_exp_f32 v127, v127
    v_exp_f32 v128, v128
    s_add_u32 m0, s57, 21504
    s_mov_b32 s59, 86016
    v_exp_f32 v129, v129
    v_smfmac_f32_32x32x32_bf16 v[152:167], v[216:219], v[120:127], v18
    ds_read_b128 v[184:187], v6 offset:18432
    ds_read_b128 v[188:191], v6 offset:19456
    buffer_load_dwordx4 v78, s[16:19], s59 offen lds
    v_exp_f32 v130, v130
    v_exp_f32 v131, v131
    v_exp_f32 v132, v132
    v_exp_f32 v133, v133
    s_waitcnt lgkmcnt(2)
    v_mfma_f32_32x32x16_bf16 v[104:119], v[168:171], v[96:99], 0
    v_exp_f32 v134, v134
    v_exp_f32 v135, v135
    v_exp_f32 v136, v136
    s_mov_b32 m0, s56
    s_xor_b32 s51, s58, 147456
    v_exp_f32 v137, v137
    v_smfmac_f32_32x32x32_bf16 v[152:167], v[220:223], v[128:135], v18
    buffer_load_dwordx4 v5, s[20:23], s51 offen offset:0 sc1 lds
    v_exp_f32 v138, v138
    v_exp_f32 v139, v139
    v_exp_f32 v140, v140
    v_exp_f32 v141, v141
    v_mfma_f32_32x32x16_bf16 v[104:119], v[172:175], v[100:103], v[104:119]
    ds_read_b128 v[192:195], v6 offset:22528
    ds_read_b128 v[196:199], v6 offset:23552
    buffer_load_dwordx4 v5, s[20:23], s51 offen offset:1024 sc1 lds
    v_exp_f32 v142, v142
    v_exp_f32 v143, v143
    v_exp_f32 v144, v144
    v_exp_f32 v145, v145
    v_smfmac_f32_32x32x32_bf16 v[152:167], v[224:227], v[136:143], v18
    s_mov_b32 s52, 0
    buffer_load_dwordx4 v[24:27], v8, s[36:39], s52 offen
    v_exp_f32 v146, v146
    v_exp_f32 v147, v147
    v_exp_f32 v148, v148
    v_exp_f32 v149, v149
    v_mfma_f32_32x32x16_bf16 v[120:135], v[176:179], v[96:99], 0
    s_mov_b32 s52, 57344
    buffer_load_dwordx4 v[28:31], v8, s[36:39], s52 offen
    v_exp_f32 v150, v150
    v_exp_f32 v151, v151
    s_waitcnt vmcnt(9) lgkmcnt(0)
    s_barrier
    ds_read_b128 v[200:203], v6 offset:32768
    ds_read_b128 v[204:207], v6 offset:33792
    v_exp_f32 v104, v104
    v_exp_f32 v105, v105
    v_smfmac_f32_32x32x32_bf16 v[152:167], v[228:231], v[144:151], v18
    v_exp_f32 v106, v106
    v_exp_f32 v107, v107
    v_exp_f32 v108, v108
    v_exp_f32 v109, v109
    v_mfma_f32_32x32x16_bf16 v[120:135], v[180:183], v[100:103], v[120:135]
    ds_read_b128 v[208:211], v6 offset:36864
    ds_read_b128 v[212:215], v6 offset:37888
    v_exp_f32 v110, v110
    v_exp_f32 v111, v111
    v_exp_f32 v112, v112
    s_add_u32 m0, s57, 28672
    s_mov_b32 s59, 114688
    v_exp_f32 v113, v113
    v_smfmac_f32_32x32x32_bf16 v[152:167], v[184:187], v[104:111], v18
    ds_read_b128 v[216:219], v6 offset:34816
    ds_read_b128 v[220:223], v6 offset:35840
    buffer_load_dwordx4 v78, s[16:19], s59 offen lds
    v_exp_f32 v114, v114
    v_exp_f32 v115, v115
    v_exp_f32 v116, v116
    v_exp_f32 v117, v117
    s_waitcnt lgkmcnt(2)
    v_mfma_f32_32x32x16_bf16 v[136:151], v[200:203], v[96:99], 0
    v_exp_f32 v118, v118
    v_exp_f32 v119, v119
    v_exp_f32 v120, v120
    s_add_u32 m0, s56, 16384
    s_xor_b32 s51, s58, 163840
    v_exp_f32 v121, v121
    v_smfmac_f32_32x32x32_bf16 v[152:167], v[188:191], v[112:119], v18
    buffer_load_dwordx4 v5, s[20:23], s51 offen offset:0 sc1 lds
    v_exp_f32 v122, v122
    v_exp_f32 v123, v123
    v_exp_f32 v124, v124
    v_exp_f32 v125, v125
    v_mfma_f32_32x32x16_bf16 v[136:151], v[204:207], v[100:103], v[136:151]
    ds_read_b128 v[224:227], v6 offset:38912
    ds_read_b128 v[228:231], v6 offset:39936
    buffer_load_dwordx4 v5, s[20:23], s51 offen offset:1024 sc1 lds
    v_exp_f32 v126, v126
    v_exp_f32 v127, v127
    v_exp_f32 v128, v128
    v_exp_f32 v129, v129
    v_smfmac_f32_32x32x32_bf16 v[152:167], v[192:195], v[120:127], v18
    s_mov_b32 s52, 114688
    buffer_load_dwordx4 v[32:35], v8, s[36:39], s52 offen
    v_exp_f32 v130, v130
    v_exp_f32 v131, v131
    v_exp_f32 v132, v132
    v_exp_f32 v133, v133
    v_mfma_f32_32x32x16_bf16 v[104:119], v[208:211], v[96:99], 0
    v_exp_f32 v134, v134
    v_exp_f32 v135, v135
    s_waitcnt vmcnt(10) lgkmcnt(0)
    s_barrier
    ds_read_b128 v[168:171], v6 offset:49152
    ds_read_b128 v[172:175], v6 offset:50176
    v_exp_f32 v136, v136
    v_exp_f32 v137, v137
    v_smfmac_f32_32x32x32_bf16 v[152:167], v[196:199], v[128:135], v18
    v_exp_f32 v138, v138
    v_exp_f32 v139, v139
    v_exp_f32 v140, v140
    v_exp_f32 v141, v141
    v_mfma_f32_32x32x16_bf16 v[104:119], v[212:215], v[100:103], v[104:119]
    ds_read_b128 v[176:179], v6 offset:53248
    ds_read_b128 v[180:183], v6 offset:54272
    v_exp_f32 v142, v142
    v_exp_f32 v143, v143
    v_exp_f32 v144, v144
    s_add_u32 m0, s57, 35840
    s_mov_b32 s59, 143360
    v_exp_f32 v145, v145
    v_smfmac_f32_32x32x32_bf16 v[152:167], v[216:219], v[136:143], v18
    ds_read_b128 v[184:187], v6 offset:51200
    ds_read_b128 v[188:191], v6 offset:52224
    buffer_load_dwordx4 v78, s[16:19], s59 offen lds
    v_exp_f32 v146, v146
    v_exp_f32 v147, v147
    v_exp_f32 v148, v148
    v_exp_f32 v149, v149
    s_waitcnt lgkmcnt(2)
    v_mfma_f32_32x32x16_bf16 v[120:135], v[168:171], v[96:99], 0
    v_exp_f32 v150, v150
    v_exp_f32 v151, v151
    v_exp_f32 v104, v104
    s_add_u32 m0, s56, 32768
    s_xor_b32 s51, s58, 180224
    v_exp_f32 v105, v105
    v_smfmac_f32_32x32x32_bf16 v[152:167], v[220:223], v[144:151], v18
    buffer_load_dwordx4 v5, s[20:23], s51 offen offset:0 sc1 lds
    v_exp_f32 v106, v106
    v_exp_f32 v107, v107
    v_exp_f32 v108, v108
    v_exp_f32 v109, v109
    v_mfma_f32_32x32x16_bf16 v[120:135], v[172:175], v[100:103], v[120:135]
    ds_read_b128 v[192:195], v6 offset:55296
    ds_read_b128 v[196:199], v6 offset:56320
    buffer_load_dwordx4 v5, s[20:23], s51 offen offset:1024 sc1 lds
    v_exp_f32 v110, v110
    v_exp_f32 v111, v111
    v_exp_f32 v112, v112
    s_add_u32 m0, s57, 43008
    s_mov_b32 s59, 172032
    v_exp_f32 v113, v113
    v_smfmac_f32_32x32x32_bf16 v[152:167], v[224:227], v[104:111], v18
    buffer_load_dwordx4 v78, s[16:19], s59 offen lds
    v_exp_f32 v114, v114
    v_exp_f32 v115, v115
    v_exp_f32 v116, v116
    v_exp_f32 v117, v117
    v_mfma_f32_32x32x16_bf16 v[136:151], v[176:179], v[96:99], 0
    s_mov_b32 s52, 172032
    buffer_load_dwordx4 v[36:39], v8, s[36:39], s52 offen
    v_exp_f32 v118, v118
    v_exp_f32 v119, v119
    s_waitcnt vmcnt(11) lgkmcnt(0)
    s_barrier
    ds_read_b128 v[200:203], v6 offset:0
    ds_read_b128 v[204:207], v6 offset:1024
    v_exp_f32 v120, v120
    v_exp_f32 v121, v121
    v_smfmac_f32_32x32x32_bf16 v[152:167], v[228:231], v[112:119], v18
    v_exp_f32 v122, v122
    v_exp_f32 v123, v123
    v_exp_f32 v124, v124
    v_exp_f32 v125, v125
    v_mfma_f32_32x32x16_bf16 v[136:151], v[180:183], v[100:103], v[136:151]
    ds_read_b128 v[208:211], v6 offset:4096
    ds_read_b128 v[212:215], v6 offset:5120
    v_exp_f32 v126, v126
    v_exp_f32 v127, v127
    v_exp_f32 v128, v128
    s_add_u32 m0, s57, 50176
    s_mov_b32 s59, 200704
    v_exp_f32 v129, v129
    v_smfmac_f32_32x32x32_bf16 v[152:167], v[184:187], v[120:127], v18
    ds_read_b128 v[216:219], v6 offset:2048
    ds_read_b128 v[220:223], v6 offset:3072
    buffer_load_dwordx4 v78, s[16:19], s59 offen lds
    v_exp_f32 v130, v130
    v_exp_f32 v131, v131
    v_exp_f32 v132, v132
    v_exp_f32 v133, v133
    s_waitcnt lgkmcnt(2)
    v_mfma_f32_32x32x16_bf16 v[104:119], v[200:203], v[96:99], 0
    v_exp_f32 v134, v134
    v_exp_f32 v135, v135
    v_exp_f32 v136, v136
    s_add_u32 m0, s56, 49152
    s_xor_b32 s51, s58, 196608
    v_exp_f32 v137, v137
    v_smfmac_f32_32x32x32_bf16 v[152:167], v[188:191], v[128:135], v18
    buffer_load_dwordx4 v5, s[20:23], s51 offen offset:0 sc1 lds
    v_exp_f32 v138, v138
    v_exp_f32 v139, v139
    v_exp_f32 v140, v140
    v_exp_f32 v141, v141
    v_mfma_f32_32x32x16_bf16 v[104:119], v[204:207], v[100:103], v[104:119]
    ds_read_b128 v[224:227], v6 offset:6144
    ds_read_b128 v[228:231], v6 offset:7168
    buffer_load_dwordx4 v5, s[20:23], s51 offen offset:1024 sc1 lds
    v_exp_f32 v142, v142
    v_exp_f32 v143, v143
    v_exp_f32 v144, v144
    v_exp_f32 v145, v145
    v_smfmac_f32_32x32x32_bf16 v[152:167], v[192:195], v[136:143], v18
    s_mov_b32 s52, 229376
    buffer_load_dwordx4 v[40:43], v8, s[36:39], s52 offen
    v_exp_f32 v146, v146
    v_exp_f32 v147, v147
    v_exp_f32 v148, v148
    v_exp_f32 v149, v149
    v_mfma_f32_32x32x16_bf16 v[120:135], v[208:211], v[96:99], 0
    v_exp_f32 v150, v150
    v_exp_f32 v151, v151
    s_waitcnt vmcnt(10) lgkmcnt(0)
    s_barrier
    ds_read_b128 v[168:171], v6 offset:16384
    ds_read_b128 v[172:175], v6 offset:17408
    v_exp_f32 v104, v104
    v_exp_f32 v105, v105
    v_smfmac_f32_32x32x32_bf16 v[152:167], v[196:199], v[144:151], v18
    v_exp_f32 v106, v106
    v_exp_f32 v107, v107
    v_exp_f32 v108, v108
    v_exp_f32 v109, v109
    v_mfma_f32_32x32x16_bf16 v[120:135], v[212:215], v[100:103], v[120:135]
    ds_read_b128 v[176:179], v6 offset:20480
    ds_read_b128 v[180:183], v6 offset:21504
    v_exp_f32 v110, v110
    v_exp_f32 v111, v111
    v_exp_f32 v112, v112
    s_add_u32 m0, s57, 57344
    s_mov_b32 s59, 229376
    v_exp_f32 v113, v113
    v_smfmac_f32_32x32x32_bf16 v[152:167], v[216:219], v[104:111], v18
    ds_read_b128 v[184:187], v6 offset:18432
    ds_read_b128 v[188:191], v6 offset:19456
    buffer_load_dwordx4 v78, s[16:19], s59 offen lds
    v_exp_f32 v114, v114
    v_exp_f32 v115, v115
    v_exp_f32 v116, v116
    v_exp_f32 v117, v117
    s_waitcnt lgkmcnt(2)
    v_mfma_f32_32x32x16_bf16 v[136:151], v[168:171], v[96:99], 0
    v_exp_f32 v118, v118
    v_exp_f32 v119, v119
    v_exp_f32 v120, v120
    s_mov_b32 m0, s56
    s_xor_b32 s51, s58, 212992
    v_exp_f32 v121, v121
    v_smfmac_f32_32x32x32_bf16 v[152:167], v[220:223], v[112:119], v18
    buffer_load_dwordx4 v5, s[20:23], s51 offen offset:0 sc1 lds
    v_exp_f32 v122, v122
    v_exp_f32 v123, v123
    v_exp_f32 v124, v124
    v_exp_f32 v125, v125
    v_mfma_f32_32x32x16_bf16 v[136:151], v[172:175], v[100:103], v[136:151]
    ds_read_b128 v[192:195], v6 offset:22528
    ds_read_b128 v[196:199], v6 offset:23552
    buffer_load_dwordx4 v5, s[20:23], s51 offen offset:1024 sc1 lds
    v_exp_f32 v126, v126
    v_exp_f32 v127, v127
    v_exp_f32 v128, v128
    v_exp_f32 v129, v129
    v_smfmac_f32_32x32x32_bf16 v[152:167], v[224:227], v[120:127], v18
    s_mov_b32 s52, 286720
    buffer_load_dwordx4 v[44:47], v8, s[36:39], s52 offen
    v_exp_f32 v130, v130
    v_exp_f32 v131, v131
    v_exp_f32 v132, v132
    v_exp_f32 v133, v133
    v_mfma_f32_32x32x16_bf16 v[104:119], v[176:179], v[96:99], 0
    v_exp_f32 v134, v134
    v_exp_f32 v135, v135
    s_waitcnt vmcnt(10) lgkmcnt(0)
    s_barrier
    ds_read_b128 v[200:203], v6 offset:32768
    ds_read_b128 v[204:207], v6 offset:33792
    v_exp_f32 v136, v136
    v_exp_f32 v137, v137
    v_smfmac_f32_32x32x32_bf16 v[152:167], v[228:231], v[128:135], v18
    v_exp_f32 v138, v138
    v_exp_f32 v139, v139
    v_exp_f32 v140, v140
    v_exp_f32 v141, v141
    v_mfma_f32_32x32x16_bf16 v[104:119], v[180:183], v[100:103], v[104:119]
    ds_read_b128 v[208:211], v6 offset:36864
    ds_read_b128 v[212:215], v6 offset:37888
    v_exp_f32 v142, v142
    v_exp_f32 v143, v143
    v_exp_f32 v144, v144
    s_add_u32 m0, s57, 64512
    s_mov_b32 s59, 258048
    v_exp_f32 v145, v145
    v_smfmac_f32_32x32x32_bf16 v[152:167], v[184:187], v[136:143], v18
    ds_read_b128 v[216:219], v6 offset:34816
    ds_read_b128 v[220:223], v6 offset:35840
    buffer_load_dwordx4 v78, s[16:19], s59 offen lds
    v_exp_f32 v146, v146
    v_exp_f32 v147, v147
    v_exp_f32 v148, v148
    v_exp_f32 v149, v149
    s_waitcnt lgkmcnt(2)
    v_mfma_f32_32x32x16_bf16 v[120:135], v[200:203], v[96:99], 0
    v_exp_f32 v150, v150
    v_exp_f32 v151, v151
    v_exp_f32 v104, v104
    s_add_u32 m0, s56, 16384
    s_xor_b32 s51, s58, 229376
    v_exp_f32 v105, v105
    v_smfmac_f32_32x32x32_bf16 v[152:167], v[188:191], v[144:151], v18
    buffer_load_dwordx4 v5, s[20:23], s51 offen offset:0 sc1 lds
    v_exp_f32 v106, v106
    v_exp_f32 v107, v107
    v_exp_f32 v108, v108
    v_exp_f32 v109, v109
    v_mfma_f32_32x32x16_bf16 v[120:135], v[204:207], v[100:103], v[120:135]
    ds_read_b128 v[224:227], v6 offset:38912
    ds_read_b128 v[228:231], v6 offset:39936
    buffer_load_dwordx4 v5, s[20:23], s51 offen offset:1024 sc1 lds
    v_exp_f32 v110, v110
    v_exp_f32 v111, v111
    v_exp_f32 v112, v112
    v_exp_f32 v113, v113
    v_smfmac_f32_32x32x32_bf16 v[152:167], v[192:195], v[104:111], v18
    s_mov_b32 s52, 344064
    buffer_load_dwordx4 v[48:51], v8, s[36:39], s52 offen
    v_exp_f32 v114, v114
    v_exp_f32 v115, v115
    v_exp_f32 v116, v116
    v_exp_f32 v117, v117
    v_mfma_f32_32x32x16_bf16 v[136:151], v[208:211], v[96:99], 0
    s_mul_i32 s52, s47, 28672
    buffer_load_dwordx4 v[52:55], v7, s[4:7], s52 offen
    v_exp_f32 v118, v118
    v_exp_f32 v119, v119
    s_waitcnt vmcnt(10) lgkmcnt(0)
    s_barrier
    ds_read_b128 v[168:171], v6 offset:49152
    ds_read_b128 v[172:175], v6 offset:50176
    v_exp_f32 v120, v120
    v_exp_f32 v121, v121
    v_smfmac_f32_32x32x32_bf16 v[152:167], v[196:199], v[112:119], v18
    v_exp_f32 v122, v122
    v_exp_f32 v123, v123
    v_exp_f32 v124, v124
    v_exp_f32 v125, v125
    v_mfma_f32_32x32x16_bf16 v[136:151], v[212:215], v[100:103], v[136:151]
    ds_read_b128 v[176:179], v6 offset:53248
    ds_read_b128 v[180:183], v6 offset:54272
    v_exp_f32 v126, v126
    v_exp_f32 v127, v127
    v_exp_f32 v128, v128
    s_add_u32 m0, s57, 71680
    s_mov_b32 s59, 286720
    v_exp_f32 v129, v129
    v_smfmac_f32_32x32x32_bf16 v[152:167], v[216:219], v[120:127], v18
    ds_read_b128 v[184:187], v6 offset:51200
    ds_read_b128 v[188:191], v6 offset:52224
    buffer_load_dwordx4 v78, s[16:19], s59 offen lds
    v_exp_f32 v130, v130
    v_exp_f32 v131, v131
    v_exp_f32 v132, v132
    v_exp_f32 v133, v133
    s_waitcnt lgkmcnt(2)
    v_mfma_f32_32x32x16_bf16 v[104:119], v[168:171], v[96:99], 0
    v_exp_f32 v134, v134
    v_exp_f32 v135, v135
    v_exp_f32 v136, v136
    s_add_u32 m0, s56, 32768
    s_xor_b32 s51, s58, 245760
    v_exp_f32 v137, v137
    v_smfmac_f32_32x32x32_bf16 v[152:167], v[220:223], v[128:135], v18
    buffer_load_dwordx4 v5, s[20:23], s51 offen offset:0 sc1 lds
    v_exp_f32 v138, v138
    v_exp_f32 v139, v139
    v_exp_f32 v140, v140
    v_exp_f32 v141, v141
    v_mfma_f32_32x32x16_bf16 v[104:119], v[172:175], v[100:103], v[104:119]
    ds_read_b128 v[192:195], v6 offset:55296
    ds_read_b128 v[196:199], v6 offset:56320
    buffer_load_dwordx4 v5, s[20:23], s51 offen offset:1024 sc1 lds
    v_exp_f32 v142, v142
    v_exp_f32 v143, v143
    v_exp_f32 v144, v144
    s_add_u32 m0, s57, 78848
    s_mov_b32 s59, 315392
    v_exp_f32 v145, v145
    v_smfmac_f32_32x32x32_bf16 v[152:167], v[224:227], v[136:143], v18
    buffer_load_dwordx4 v78, s[16:19], s59 offen lds
    v_exp_f32 v146, v146
    v_exp_f32 v147, v147
    v_exp_f32 v148, v148
    v_exp_f32 v149, v149
    v_mfma_f32_32x32x16_bf16 v[120:135], v[176:179], v[96:99], 0
    buffer_load_dwordx4 v[80:83], v2, s[8:11], s73 offen offset:0
    buffer_load_dwordx2 v[56:57], v17, s[32:35], 0 offen
    buffer_load_dwordx4 v[60:63], v2, s[32:35], 0 offen
    v_exp_f32 v150, v150
    v_exp_f32 v151, v151
    s_waitcnt vmcnt(13) lgkmcnt(0)
    s_barrier
    ds_read_b128 v[200:203], v6 offset:0
    ds_read_b128 v[204:207], v6 offset:1024
    v_exp_f32 v104, v104
    v_exp_f32 v105, v105
    v_smfmac_f32_32x32x32_bf16 v[152:167], v[228:231], v[144:151], v18
    v_exp_f32 v106, v106
    v_exp_f32 v107, v107
    v_exp_f32 v108, v108
    v_exp_f32 v109, v109
    v_mfma_f32_32x32x16_bf16 v[120:135], v[180:183], v[100:103], v[120:135]
    ds_read_b128 v[208:211], v6 offset:4096
    ds_read_b128 v[212:215], v6 offset:5120
    v_exp_f32 v110, v110
    v_exp_f32 v111, v111
    v_exp_f32 v112, v112
    s_add_u32 m0, s57, 86016
    s_mov_b32 s59, 344064
    v_exp_f32 v113, v113
    v_smfmac_f32_32x32x32_bf16 v[152:167], v[184:187], v[104:111], v18
    ds_read_b128 v[216:219], v6 offset:2048
    ds_read_b128 v[220:223], v6 offset:3072
    buffer_load_dwordx4 v78, s[16:19], s59 offen lds
    v_exp_f32 v114, v114
    v_exp_f32 v115, v115
    v_exp_f32 v116, v116
    v_exp_f32 v117, v117
    s_waitcnt lgkmcnt(2)
    v_mfma_f32_32x32x16_bf16 v[136:151], v[200:203], v[96:99], 0
    v_exp_f32 v118, v118
    v_exp_f32 v119, v119
    v_exp_f32 v120, v120
    v_exp_f32 v121, v121
    v_smfmac_f32_32x32x32_bf16 v[152:167], v[188:191], v[112:119], v18
    v_exp_f32 v122, v122
    v_exp_f32 v123, v123
    v_exp_f32 v124, v124
    v_exp_f32 v125, v125
    v_mfma_f32_32x32x16_bf16 v[136:151], v[204:207], v[100:103], v[136:151]
    ds_read_b128 v[224:227], v6 offset:6144
    ds_read_b128 v[228:231], v6 offset:7168
    v_exp_f32 v126, v126
    v_exp_f32 v127, v127
    v_exp_f32 v128, v128
    v_exp_f32 v129, v129
    v_smfmac_f32_32x32x32_bf16 v[152:167], v[192:195], v[120:127], v18
    buffer_load_dwordx4 v[84:87], v2, s[8:11], s73 offen offset:896
    v_exp_f32 v130, v130
    v_exp_f32 v131, v131
    v_exp_f32 v132, v132
    v_exp_f32 v133, v133
    v_mfma_f32_32x32x16_bf16 v[104:119], v[208:211], v[96:99], 0
    s_mov_b32 s52, 8388612
    buffer_load_dword v70, v16, s[20:23], s52 offen sc1
    v_exp_f32 v134, v134
    v_exp_f32 v135, v135
    s_waitcnt vmcnt(12) lgkmcnt(0)
    s_barrier
    ds_read_b128 v[168:171], v6 offset:16384
    ds_read_b128 v[172:175], v6 offset:17408
    v_exp_f32 v136, v136
    v_exp_f32 v137, v137
    v_smfmac_f32_32x32x32_bf16 v[152:167], v[196:199], v[128:135], v18
    v_exp_f32 v138, v138
    v_exp_f32 v139, v139
    v_exp_f32 v140, v140
    v_exp_f32 v141, v141
    v_mfma_f32_32x32x16_bf16 v[104:119], v[212:215], v[100:103], v[104:119]
    ds_read_b128 v[176:179], v6 offset:20480
    ds_read_b128 v[180:183], v6 offset:21504
    v_exp_f32 v142, v142
    v_exp_f32 v143, v143
    v_exp_f32 v144, v144
    s_add_u32 m0, s57, 93184
    s_mov_b32 s59, 372736
    v_exp_f32 v145, v145
    v_smfmac_f32_32x32x32_bf16 v[152:167], v[216:219], v[136:143], v18
    ds_read_b128 v[184:187], v6 offset:18432
    ds_read_b128 v[188:191], v6 offset:19456
    buffer_load_dwordx4 v78, s[16:19], s59 offen lds
    v_exp_f32 v146, v146
    v_exp_f32 v147, v147
    v_exp_f32 v148, v148
    v_exp_f32 v149, v149
    s_waitcnt lgkmcnt(2)
    v_mfma_f32_32x32x16_bf16 v[120:135], v[168:171], v[96:99], 0
    v_exp_f32 v150, v150
    v_exp_f32 v151, v151
    v_exp_f32 v104, v104
    v_exp_f32 v105, v105
    v_smfmac_f32_32x32x32_bf16 v[152:167], v[220:223], v[144:151], v18
    v_exp_f32 v106, v106
    v_exp_f32 v107, v107
    v_exp_f32 v108, v108
    v_exp_f32 v109, v109
    v_mfma_f32_32x32x16_bf16 v[120:135], v[172:175], v[100:103], v[120:135]
    ds_read_b128 v[192:195], v6 offset:22528
    ds_read_b128 v[196:199], v6 offset:23552
    v_exp_f32 v110, v110
    v_exp_f32 v111, v111
    v_exp_f32 v112, v112
    v_exp_f32 v113, v113
    v_smfmac_f32_32x32x32_bf16 v[152:167], v[224:227], v[104:111], v18
    buffer_load_dwordx4 v[88:91], v2, s[8:11], s73 offen offset:1792
    v_exp_f32 v114, v114
    v_exp_f32 v115, v115
    v_exp_f32 v116, v116
    v_exp_f32 v117, v117
    v_mfma_f32_32x32x16_bf16 v[136:151], v[176:179], v[96:99], 0
    v_exp_f32 v118, v118
    v_exp_f32 v119, v119
    s_waitcnt vmcnt(9) lgkmcnt(0)
    s_barrier
    ds_read_b128 v[200:203], v6 offset:32768
    ds_read_b128 v[204:207], v6 offset:33792
    v_exp_f32 v120, v120
    v_exp_f32 v121, v121
    v_smfmac_f32_32x32x32_bf16 v[152:167], v[228:231], v[112:119], v18
    v_exp_f32 v122, v122
    v_exp_f32 v123, v123
    v_exp_f32 v124, v124
    v_exp_f32 v125, v125
    v_mfma_f32_32x32x16_bf16 v[136:151], v[180:183], v[100:103], v[136:151]
    ds_read_b128 v[208:211], v6 offset:36864
    ds_read_b128 v[212:215], v6 offset:37888
    v_exp_f32 v126, v126
    v_exp_f32 v127, v127
    v_exp_f32 v128, v128
    s_mov_b32 m0, s57
    s_mov_b32 s59, 0
    v_exp_f32 v129, v129
    v_smfmac_f32_32x32x32_bf16 v[152:167], v[184:187], v[120:127], v18
    ds_read_b128 v[216:219], v6 offset:34816
    ds_read_b128 v[220:223], v6 offset:35840
    buffer_load_dwordx4 v78, s[16:19], s59 offen lds
    v_exp_f32 v130, v130
    v_exp_f32 v131, v131
    v_exp_f32 v132, v132
    v_exp_f32 v133, v133
    s_waitcnt lgkmcnt(2)
    v_mfma_f32_32x32x16_bf16 v[104:119], v[200:203], v[96:99], 0
    v_exp_f32 v134, v134
    v_exp_f32 v135, v135
    v_exp_f32 v136, v136
    v_exp_f32 v137, v137
    v_smfmac_f32_32x32x32_bf16 v[152:167], v[188:191], v[128:135], v18
    v_exp_f32 v138, v138
    v_exp_f32 v139, v139
    v_exp_f32 v140, v140
    v_exp_f32 v141, v141
    v_mfma_f32_32x32x16_bf16 v[104:119], v[204:207], v[100:103], v[104:119]
    ds_read_b128 v[224:227], v6 offset:38912
    ds_read_b128 v[228:231], v6 offset:39936
    v_exp_f32 v142, v142
    v_exp_f32 v143, v143
    v_exp_f32 v144, v144
    v_exp_f32 v145, v145
    v_smfmac_f32_32x32x32_bf16 v[152:167], v[192:195], v[136:143], v18
    buffer_load_dwordx4 v[92:95], v2, s[8:11], s73 offen offset:2688
    v_exp_f32 v146, v146
    v_exp_f32 v147, v147
    v_exp_f32 v148, v148
    v_exp_f32 v149, v149
    v_mfma_f32_32x32x16_bf16 v[120:135], v[208:211], v[96:99], 0
    v_exp_f32 v150, v150
    v_exp_f32 v151, v151
    s_waitcnt lgkmcnt(0)
    s_barrier
    v_exp_f32 v104, v104
    v_exp_f32 v105, v105
    v_smfmac_f32_32x32x32_bf16 v[152:167], v[196:199], v[144:151], v18
    v_exp_f32 v106, v106
    v_exp_f32 v107, v107
    v_exp_f32 v108, v108
    v_exp_f32 v109, v109
    v_mfma_f32_32x32x16_bf16 v[120:135], v[212:215], v[100:103], v[120:135]
    v_exp_f32 v110, v110
    v_exp_f32 v111, v111
    v_exp_f32 v112, v112
    v_exp_f32 v113, v113
    v_smfmac_f32_32x32x32_bf16 v[152:167], v[216:219], v[104:111], v18
    s_waitcnt vmcnt(4)
    v_cmp_gt_u32 vcc, 16, v70
    s_and_b32 vcc_lo, vcc_lo, 0xffff
    s_cbranch_scc1 L_20
L_21:
    v_exp_f32 v114, v114
    v_exp_f32 v115, v115
    v_exp_f32 v116, v116
    v_exp_f32 v117, v117
    v_exp_f32 v118, v118
    v_exp_f32 v119, v119
    v_exp_f32 v120, v120
    v_exp_f32 v121, v121
    v_smfmac_f32_32x32x32_bf16 v[152:167], v[220:223], v[112:119], v18
    v_exp_f32 v122, v122
    v_exp_f32 v123, v123
    v_exp_f32 v124, v124
    v_exp_f32 v125, v125
    v_exp_f32 v126, v126
    v_exp_f32 v127, v127
    v_exp_f32 v128, v128
    v_exp_f32 v129, v129
    v_smfmac_f32_32x32x32_bf16 v[152:167], v[224:227], v[120:127], v18
    v_exp_f32 v130, v130
    v_exp_f32 v131, v131
    v_exp_f32 v132, v132
    v_exp_f32 v133, v133
    v_exp_f32 v134, v134
    v_exp_f32 v135, v135
    s_branch L_tail0
L_loopf1:
    s_waitcnt vmcnt(4) lgkmcnt(0)
    s_barrier
    ds_read_b128 v[200:203], v6 offset:0
    ds_read_b128 v[204:207], v6 offset:1024
    v_exp_f32 v104, v104
    s_add_u32 m0, s56, 49152
    s_xor_b32 s51, s58, 65536
    v_exp_f32 v105, v105
    buffer_load_dwordx4 v5, s[20:23], s51 offen offset:0 sc1 lds
    v_exp_f32 v106, v106
    v_exp_f32 v107, v107
    v_exp_f32 v108, v108
    v_exp_f32 v109, v109
    v_mfma_f32_32x32x16_bf16 v[120:135], v[180:183], v[100:103], v[120:135]
    ds_read_b128 v[208:211], v6 offset:4096
    ds_read_b128 v[212:215], v6 offset:5120
    buffer_load_dwordx4 v5, s[20:23], s51 offen offset:1024 sc1 lds
    v_exp_f32 v110, v110
    v_exp_f32 v111, v111
    v_exp_f32 v112, v112
    v_exp_f32 v113, v113
    v_smfmac_f32_32x32x32_bf16 v[152:167], v[184:187], v[104:111], v18
    ds_read_b128 v[216:219], v6 offset:2048
    ds_read_b128 v[220:223], v6 offset:3072
    v_exp_f32 v114, v114
    v_exp_f32 v115, v115
    v_exp_f32 v116, v116
    v_exp_f32 v117, v117
    s_waitcnt lgkmcnt(2)
    v_mfma_f32_32x32x16_bf16 v[136:151], v[200:203], v[96:99], 0
    v_exp_f32 v118, v118
    v_exp_f32 v119, v119
    v_exp_f32 v120, v120
    v_exp_f32 v121, v121
    v_smfmac_f32_32x32x32_bf16 v[152:167], v[188:191], v[112:119], v18
    v_exp_f32 v122, v122
    v_exp_f32 v123, v123
    v_exp_f32 v124, v124
    v_exp_f32 v125, v125
    v_mfma_f32_32x32x16_bf16 v[136:151], v[204:207], v[100:103], v[136:151]
    ds_read_b128 v[224:227], v6 offset:6144
    ds_read_b128 v[228:231], v6 offset:7168
    v_exp_f32 v126, v126
    v_exp_f32 v127, v127
    v_exp_f32 v128, v128
    v_exp_f32 v129, v129
    v_smfmac_f32_32x32x32_bf16 v[152:167], v[192:195], v[120:127], v18
    v_exp_f32 v130, v130
    v_exp_f32 v131, v131
    v_exp_f32 v132, v132
    v_exp_f32 v133, v133
    v_mfma_f32_32x32x16_bf16 v[104:119], v[208:211], v[96:99], 0
    v_exp_f32 v134, v134
    v_exp_f32 v135, v135
    s_waitcnt vmcnt(4) lgkmcnt(0)
    s_barrier
    ds_read_b128 v[168:171], v6 offset:16384
    ds_read_b128 v[172:175], v6 offset:17408
    v_exp_f32 v136, v136
    s_mov_b32 m0, s56
    s_xor_b32 s51, s58, 81920
    v_exp_f32 v137, v137
    v_smfmac_f32_32x32x32_bf16 v[152:167], v[196:199], v[128:135], v18
    buffer_load_dwordx4 v5, s[20:23], s51 offen offset:0 sc1 lds
    v_exp_f32 v138, v138
    v_exp_f32 v139, v139
    v_exp_f32 v140, v140
    v_exp_f32 v141, v141
    v_mfma_f32_32x32x16_bf16 v[104:119], v[212:215], v[100:103], v[104:119]
    ds_read_b128 v[176:179], v6 offset:20480
    ds_read_b128 v[180:183], v6 offset:21504
    buffer_load_dwordx4 v5, s[20:23], s51 offen offset:1024 sc1 lds
    v_exp_f32 v142, v142
    v_exp_f32 v143, v143
    v_exp_f32 v144, v144
    v_exp_f32 v145, v145
    v_smfmac_f32_32x32x32_bf16 v[152:167], v[216:219], v[136:143], v18
    ds_read_b128 v[184:187], v6 offset:18432
    ds_read_b128 v[188:191], v6 offset:19456
    s_add_u32 s52, s40, s63
    s_cmp_lg_u32 s52, 0
    s_cbranch_scc1 L_22
    s_lshl_b32 s52, s43, 10
    s_add_u32 s52, s52, 8388612
    s_mov_b64 exec, 1
    v_mov_b32 v10, 1
    buffer_atomic_add v10, v2, s[20:23], s52 offen sc1
    s_mov_b64 exec, -1
L_22:
    v_exp_f32 v146, v146
    v_exp_f32 v147, v147
    v_exp_f32 v148, v148
    v_exp_f32 v149, v149
    s_waitcnt lgkmcnt(2)
    v_mfma_f32_32x32x16_bf16 v[120:135], v[168:171], v[96:99], 0
    v_exp_f32 v150, v150
    v_exp_f32 v151, v151
    v_exp_f32 v104, v104
    v_exp_f32 v105, v105
    v_smfmac_f32_32x32x32_bf16 v[152:167], v[220:223], v[144:151], v18
    v_exp_f32 v106, v106
    v_exp_f32 v107, v107
    v_exp_f32 v108, v108
    v_exp_f32 v109, v109
    v_mfma_f32_32x32x16_bf16 v[120:135], v[172:175], v[100:103], v[120:135]
    ds_read_b128 v[192:195], v6 offset:22528
    ds_read_b128 v[196:199], v6 offset:23552
    v_exp_f32 v110, v110
    v_exp_f32 v111, v111
    v_exp_f32 v112, v112
    v_exp_f32 v113, v113
    v_smfmac_f32_32x32x32_bf16 v[152:167], v[224:227], v[104:111], v18
    v_exp_f32 v114, v114
    v_exp_f32 v115, v115
    v_exp_f32 v116, v116
    v_exp_f32 v117, v117
    v_mfma_f32_32x32x16_bf16 v[136:151], v[176:179], v[96:99], 0
    v_exp_f32 v118, v118
    v_exp_f32 v119, v119
    s_waitcnt vmcnt(4) lgkmcnt(0)
    s_barrier
    ds_read_b128 v[200:203], v6 offset:32768
    ds_read_b128 v[204:207], v6 offset:33792
    v_exp_f32 v120, v120
    s_add_u32 m0, s56, 16384
    s_xor_b32 s51, s58, 98304
    v_exp_f32 v121, v121
    v_smfmac_f32_32x32x32_bf16 v[152:167], v[228:231], v[112:119], v18
    buffer_load_dwordx4 v5, s[20:23], s51 offen offset:0 sc1 lds
    v_exp_f32 v122, v122
    v_exp_f32 v123, v123
    v_exp_f32 v124, v124
    v_exp_f32 v125, v125
    v_mfma_f32_32x32x16_bf16 v[136:151], v[180:183], v[100:103], v[136:151]
    ds_read_b128 v[208:211], v6 offset:36864
    ds_read_b128 v[212:215], v6 offset:37888
    buffer_load_dwordx4 v5, s[20:23], s51 offen offset:1024 sc1 lds
    v_exp_f32 v126, v126
    v_exp_f32 v127, v127
    v_exp_f32 v128, v128
    v_exp_f32 v129, v129
    v_smfmac_f32_32x32x32_bf16 v[152:167], v[184:187], v[120:127], v18
    ds_read_b128 v[216:219], v6 offset:34816
    ds_read_b128 v[220:223], v6 offset:35840
    v_exp_f32 v130, v130
    v_exp_f32 v131, v131
    v_exp_f32 v132, v132
    v_exp_f32 v133, v133
    s_waitcnt lgkmcnt(2)
    v_mfma_f32_32x32x16_bf16 v[104:119], v[200:203], v[96:99], 0
    v_exp_f32 v134, v134
    v_exp_f32 v135, v135
    v_exp_f32 v136, v136
    v_exp_f32 v137, v137
    v_smfmac_f32_32x32x32_bf16 v[152:167], v[188:191], v[128:135], v18
    v_exp_f32 v138, v138
    v_exp_f32 v139, v139
    v_exp_f32 v140, v140
    v_exp_f32 v141, v141
    v_mfma_f32_32x32x16_bf16 v[104:119], v[204:207], v[100:103], v[104:119]
    ds_read_b128 v[224:227], v6 offset:38912
    ds_read_b128 v[228:231], v6 offset:39936
    v_exp_f32 v142, v142
    v_exp_f32 v143, v143
    v_exp_f32 v144, v144
    v_exp_f32 v145, v145
    v_smfmac_f32_32x32x32_bf16 v[152:167], v[192:195], v[136:143], v18
    v_exp_f32 v146, v146
    v_exp_f32 v147, v147
    v_exp_f32 v148, v148
    v_exp_f32 v149, v149
    v_mfma_f32_32x32x16_bf16 v[120:135], v[208:211], v[96:99], 0
    v_exp_f32 v150, v150
    v_exp_f32 v151, v151
    s_waitcnt vmcnt(4) lgkmcnt(0)
    s_barrier
    ds_read_b128 v[168:171], v6 offset:49152
    ds_read_b128 v[172:175], v6 offset:50176
    v_exp_f32 v104, v104
    s_add_u32 m0, s56, 32768
    s_xor_b32 s51, s58, 114688
    v_exp_f32 v105, v105
    v_smfmac_f32_32x32x32_bf16 v[152:167], v[196:199], v[144:151], v18
    buffer_load_dwordx4 v5, s[20:23], s51 offen offset:0 sc1 lds
    v_exp_f32 v106, v106
    v_exp_f32 v107, v107
    v_exp_f32 v108, v108
    v_exp_f32 v109, v109
    v_mfma_f32_32x32x16_bf16 v[120:135], v[212:215], v[100:103], v[120:135]
    ds_read_b128 v[176:179], v6 offset:53248
    ds_read_b128 v[180:183], v6 offset:54272
    buffer_load_dwordx4 v5, s[20:23], s51 offen offset:1024 sc1 lds
    v_exp_f32 v110, v110
    v_exp_f32 v111, v111
    v_exp_f32 v112, v112
    v_exp_f32 v113, v113
    v_smfmac_f32_32x32x32_bf16 v[152:167], v[216:219], v[104:111], v18
    ds_read_b128 v[184:187], v6 offset:51200
    ds_read_b128 v[188:191], v6 offset:52224
    v_exp_f32 v114, v114
    v_exp_f32 v115, v115
    v_exp_f32 v116, v116
    v_exp_f32 v117, v117
    s_waitcnt lgkmcnt(2)
    v_mfma_f32_32x32x16_bf16 v[136:151], v[168:171], v[96:99], 0
    v_exp_f32 v118, v118
    v_exp_f32 v119, v119
    v_exp_f32 v120, v120
    v_exp_f32 v121, v121
    v_smfmac_f32_32x32x32_bf16 v[152:167], v[220:223], v[112:119], v18
    v_exp_f32 v122, v122
    v_exp_f32 v123, v123
    v_exp_f32 v124, v124
    v_exp_f32 v125, v125
    v_mfma_f32_32x32x16_bf16 v[136:151], v[172:175], v[100:103], v[136:151]
    ds_read_b128 v[192:195], v6 offset:55296
    ds_read_b128 v[196:199], v6 offset:56320
    v_exp_f32 v126, v126
    v_exp_f32 v127, v127
    v_exp_f32 v128, v128
    v_exp_f32 v129, v129
    v_smfmac_f32_32x32x32_bf16 v[152:167], v[224:227], v[120:127], v18
    v_exp_f32 v130, v130
    v_exp_f32 v131, v131
    v_exp_f32 v132, v132
    v_exp_f32 v133, v133
    v_mfma_f32_32x32x16_bf16 v[104:119], v[176:179], v[96:99], 0
    v_exp_f32 v134, v134
    v_exp_f32 v135, v135
    s_waitcnt vmcnt(4) lgkmcnt(0)
    s_barrier
    ds_read_b128 v[200:203], v6 offset:0
    ds_read_b128 v[204:207], v6 offset:1024
    v_exp_f32 v136, v136
    s_add_u32 m0, s56, 49152
    s_xor_b32 s51, s58, 131072
    v_exp_f32 v137, v137
    v_smfmac_f32_32x32x32_bf16 v[152:167], v[228:231], v[128:135], v18
    buffer_load_dwordx4 v5, s[20:23], s51 offen offset:0 sc1 lds
    v_exp_f32 v138, v138
    v_exp_f32 v139, v139
    v_exp_f32 v140, v140
    v_exp_f32 v141, v141
    v_mfma_f32_32x32x16_bf16 v[104:119], v[180:183], v[100:103], v[104:119]
    ds_read_b128 v[208:211], v6 offset:4096
    ds_read_b128 v[212:215], v6 offset:5120
    buffer_load_dwordx4 v5, s[20:23], s51 offen offset:1024 sc1 lds
    v_exp_f32 v142, v142
    v_exp_f32 v143, v143
    v_exp_f32 v144, v144
    s_add_u32 m0, s57, 7168
    s_mov_b32 s59, 28672
    v_exp_f32 v145, v145
    v_smfmac_f32_32x32x32_bf16 v[152:167], v[184:187], v[136:143], v18
    ds_read_b128 v[216:219], v6 offset:2048
    ds_read_b128 v[220:223], v6 offset:3072
    buffer_load_dwordx4 v78, s[16:19], s59 offen lds
    v_exp_f32 v146, v146
    v_exp_f32 v147, v147
    v_exp_f32 v148, v148
    s_add_u32 m0, s57, 14336
    s_mov_b32 s59, 57344
    v_exp_f32 v149, v149
    s_waitcnt lgkmcnt(2)
    v_mfma_f32_32x32x16_bf16 v[120:135], v[200:203], v[96:99], 0
    buffer_load_dwordx4 v78, s[16:19], s59 offen lds
    v_exp_f32 v150, v150
    v_exp_f32 v151, v151
    v_exp_f32 v104, v104
    v_exp_f32 v105, v105
    v_smfmac_f32_32x32x32_bf16 v[152:167], v[188:191], v[144:151], v18
    v_exp_f32 v106, v106
    v_exp_f32 v107, v107
    v_exp_f32 v108, v108
    v_exp_f32 v109, v109
    v_mfma_f32_32x32x16_bf16 v[120:135], v[204:207], v[100:103], v[120:135]
    ds_read_b128 v[224:227], v6 offset:6144
    ds_read_b128 v[228:231], v6 offset:7168
    v_exp_f32 v110, v110
    v_exp_f32 v111, v111
    v_exp_f32 v112, v112
    v_exp_f32 v113, v113
    v_smfmac_f32_32x32x32_bf16 v[152:167], v[192:195], v[104:111], v18
    v_exp_f32 v114, v114
    v_exp_f32 v115, v115
    v_exp_f32 v116, v116
    v_exp_f32 v117, v117
    v_mfma_f32_32x32x16_bf16 v[136:151], v[208:211], v[96:99], 0
    v_exp_f32 v118, v118
    v_exp_f32 v119, v119
    s_waitcnt vmcnt(6) lgkmcnt(0)
    s_barrier
    ds_read_b128 v[168:171], v6 offset:16384
    ds_read_b128 v[172:175], v6 offset:17408
    v_exp_f32 v120, v120
    s_mov_b32 m0, s56
    s_xor_b32 s51, s58, 147456
    v_exp_f32 v121, v121
    v_smfmac_f32_32x32x32_bf16 v[152:167], v[196:199], v[112:119], v18
    buffer_load_dwordx4 v5, s[20:23], s51 offen offset:0 sc1 lds
    v_exp_f32 v122, v122
    v_exp_f32 v123, v123
    v_exp_f32 v124, v124
    v_exp_f32 v125, v125
    v_mfma_f32_32x32x16_bf16 v[136:151], v[212:215], v[100:103], v[136:151]
    ds_read_b128 v[176:179], v6 offset:20480
    ds_read_b128 v[180:183], v6 offset:21504
    buffer_load_dwordx4 v5, s[20:23], s51 offen offset:1024 sc1 lds
    v_exp_f32 v126, v126
    v_exp_f32 v127, v127
    v_exp_f32 v128, v128
    s_add_u32 m0, s57, 21504
    s_mov_b32 s59, 86016
    v_exp_f32 v129, v129
    v_smfmac_f32_32x32x32_bf16 v[152:167], v[216:219], v[120:127], v18
    ds_read_b128 v[184:187], v6 offset:18432
    ds_read_b128 v[188:191], v6 offset:19456
    buffer_load_dwordx4 v78, s[16:19], s59 offen lds
    v_exp_f32 v130, v130
    v_exp_f32 v131, v131
    v_exp_f32 v132, v132
    v_exp_f32 v133, v133
    s_waitcnt lgkmcnt(2)
    v_mfma_f32_32x32x16_bf16 v[104:119], v[168:171], v[96:99], 0
    s_mov_b32 s52, 0
    buffer_load_dwordx4 v[24:27], v8, s[36:39], s52 offen
    v_exp_f32 v134, v134
    v_exp_f32 v135, v135
    v_exp_f32 v136, v136
    v_exp_f32 v137, v137
    v_smfmac_f32_32x32x32_bf16 v[152:167], v[220:223], v[128:135], v18
    s_mov_b32 s52, 57344
    buffer_load_dwordx4 v[28:31], v8, s[36:39], s52 offen
    v_exp_f32 v138, v138
    v_exp_f32 v139, v139
    v_exp_f32 v140, v140
    v_exp_f32 v141, v141
    v_mfma_f32_32x32x16_bf16 v[104:119], v[172:175], v[100:103], v[104:119]
    ds_read_b128 v[192:195], v6 offset:22528
    ds_read_b128 v[196:199], v6 offset:23552
    v_exp_f32 v142, v142
    v_exp_f32 v143, v143
    v_exp_f32 v144, v144
    v_exp_f32 v145, v145
    v_smfmac_f32_32x32x32_bf16 v[152:167], v[224:227], v[136:143], v18
    v_exp_f32 v146, v146
    v_exp_f32 v147, v147
    v_exp_f32 v148, v148
    v_exp_f32 v149, v149
    v_mfma_f32_32x32x16_bf16 v[120:135], v[176:179], v[96:99], 0
    v_exp_f32 v150, v150
    v_exp_f32 v151, v151
    s_waitcnt vmcnt(9) lgkmcnt(0)
    s_barrier
    ds_read_b128 v[200:203], v6 offset:32768
    ds_read_b128 v[204:207], v6 offset:33792
    v_exp_f32 v104, v104
    s_add_u32 m0, s56, 16384
    s_xor_b32 s51, s58, 163840
    v_exp_f32 v105, v105
    v_smfmac_f32_32x32x32_bf16 v[152:167], v[228:231], v[144:151], v18
    buffer_load_dwordx4 v5, s[20:23], s51 offen offset:0 sc1 lds
    v_exp_f32 v106, v106
    v_exp_f32 v107, v107
    v_exp_f32 v108, v108
    v_exp_f32 v109, v109
    v_mfma_f32_32x32x16_bf16 v[120:135], v[180:183], v[100:103], v[120:135]
    ds_read_b128 v[208:211], v6 offset:36864
    ds_read_b128 v[212:215], v6 offset:37888
    buffer_load_dwordx4 v5, s[20:23], s51 offen offset:1024 sc1 lds
    v_exp_f32 v110, v110
    v_exp_f32 v111, v111
    v_exp_f32 v112, v112
    s_add_u32 m0, s57, 28672
    s_mov_b32 s59, 114688
    v_exp_f32 v113, v113
    v_smfmac_f32_32x32x32_bf16 v[152:167], v[184:187], v[104:111], v18
    ds_read_b128 v[216:219], v6 offset:34816
    ds_read_b128 v[220:223], v6 offset:35840
    buffer_load_dwordx4 v78, s[16:19], s59 offen lds
    v_exp_f32 v114, v114
    v_exp_f32 v115, v115
    v_exp_f32 v116, v116
    v_exp_f32 v117, v117
    s_waitcnt lgkmcnt(2)
    v_mfma_f32_32x32x16_bf16 v[136:151], v[200:203], v[96:99], 0
    s_mov_b32 s52, 114688
    buffer_load_dwordx4 v[32:35], v8, s[36:39], s52 offen
    v_exp_f32 v118, v118
    v_exp_f32 v119, v119
    v_exp_f32 v120, v120
    v_exp_f32 v121, v121
    v_smfmac_f32_32x32x32_bf16 v[152:167], v[188:191], v[112:119], v18
    v_exp_f32 v122, v122
    v_exp_f32 v123, v123
    v_exp_f32 v124, v124
    v_exp_f32 v125, v125
    v_mfma_f32_32x32x16_bf16 v[136:151], v[204:207], v[100:103], v[136:151]
    ds_read_b128 v[224:227], v6 offset:38912
    ds_read_b128 v[228:231], v6 offset:39936
    v_exp_f32 v126, v126
    v_exp_f32 v127, v127
    v_exp_f32 v128, v128
    v_exp_f32 v129, v129
    v_smfmac_f32_32x32x32_bf16 v[152:167], v[192:195], v[120:127], v18
    v_exp_f32 v130, v130
    v_exp_f32 v131, v131
    v_exp_f32 v132, v132
    v_exp_f32 v133, v133
    v_mfma_f32_32x32x16_bf16 v[104:119], v[208:211], v[96:99], 0
    v_exp_f32 v134, v134
    v_exp_f32 v135, v135
    s_waitcnt vmcnt(11) lgkmcnt(0)
    s_barrier
    ds_read_b128 v[168:171], v6 offset:49152
    ds_read_b128 v[172:175], v6 offset:50176
    v_exp_f32 v136, v136
    s_add_u32 m0, s56, 32768
    s_xor_b32 s51, s58, 180224
    v_exp_f32 v137, v137
    v_smfmac_f32_32x32x32_bf16 v[152:167], v[196:199], v[128:135], v18
    buffer_load_dwordx4 v5, s[20:23], s51 offen offset:0 sc1 lds
    v_exp_f32 v138, v138
    v_exp_f32 v139, v139
    v_exp_f32 v140, v140
    v_exp_f32 v141, v141
    v_mfma_f32_32x32x16_bf16 v[104:119], v[212:215], v[100:103], v[104:119]
    ds_read_b128 v[176:179], v6 offset:53248
    ds_read_b128 v[180:183], v6 offset:54272
    buffer_load_dwordx4 v5, s[20:23], s51 offen offset:1024 sc1 lds
    v_exp_f32 v142, v142
    v_exp_f32 v143, v143
    v_exp_f32 v144, v144
    s_add_u32 m0, s57, 35840
    s_mov_b32 s59, 143360
    v_exp_f32 v145, v145
    v_smfmac_f32_32x32x32_bf16 v[152:167], v[216:219], v[136:143], v18
    ds_read_b128 v[184:187], v6 offset:51200
    ds_read_b128 v[188:191], v6 offset:52224
    buffer_load_dwordx4 v78, s[16:19], s59 offen lds
    v_exp_f32 v146, v146
    v_exp_f32 v147, v147
    v_exp_f32 v148, v148
    s_add_u32 m0, s57, 43008
    s_mov_b32 s59, 172032
    v_exp_f32 v149, v149
    s_waitcnt lgkmcnt(2)
    v_mfma_f32_32x32x16_bf16 v[120:135], v[168:171], v[96:99], 0
    buffer_load_dwordx4 v78, s[16:19], s59 offen lds
    v_exp_f32 v150, v150
    v_exp_f32 v151, v151
    v_exp_f32 v104, v104
    v_exp_f32 v105, v105
    v_smfmac_f32_32x32x32_bf16 v[152:167], v[220:223], v[144:151], v18
    s_mov_b32 s52, 172032
    buffer_load_dwordx4 v[36:39], v8, s[36:39], s52 offen
    v_exp_f32 v106, v106
    v_exp_f32 v107, v107
    v_exp_f32 v108, v108
    v_exp_f32 v109, v109
    v_mfma_f32_32x32x16_bf16 v[120:135], v[172:175], v[100:103], v[120:135]
    ds_read_b128 v[192:195], v6 offset:55296
    ds_read_b128 v[196:199], v6 offset:56320
    v_exp_f32 v110, v110
    v_exp_f32 v111, v111
    v_exp_f32 v112, v112
    v_exp_f32 v113, v113
    v_smfmac_f32_32x32x32_bf16 v[152:167], v[224:227], v[104:111], v18
    v_exp_f32 v114, v114
    v_exp_f32 v115, v115
    v_exp_f32 v116, v116
    v_exp_f32 v117, v117
    v_mfma_f32_32x32x16_bf16 v[136:151], v[176:179], v[96:99], 0
    v_exp_f32 v118, v118
    v_exp_f32 v119, v119
    s_waitcnt vmcnt(12) lgkmcnt(0)
    s_barrier
    ds_read_b128 v[200:203], v6 offset:0
    ds_read_b128 v[204:207], v6 offset:1024
    v_exp_f32 v120, v120
    s_add_u32 m0, s56, 49152
    s_xor_b32 s51, s58, 196608
    v_exp_f32 v121, v121
    v_smfmac_f32_32x32x32_bf16 v[152:167], v[228:231], v[112:119], v18
    buffer_load_dwordx4 v5, s[20:23], s51 offen offset:0 sc1 lds
    v_exp_f32 v122, v122
    v_exp_f32 v123, v123
    v_exp_f32 v124, v124
    v_exp_f32 v125, v125
    v_mfma_f32_32x32x16_bf16 v[136:151], v[180:183], v[100:103], v[136:151]
    ds_read_b128 v[208:211], v6 offset:4096
    ds_read_b128 v[212:215], v6 offset:5120
    buffer_load_dwordx4 v5, s[20:23], s51 offen offset:1024 sc1 lds
    v_exp_f32 v126, v126
    v_exp_f32 v127, v127
    v_exp_f32 v128, v128
    s_add_u32 m0, s57, 50176
    s_mov_b32 s59, 200704
    v_exp_f32 v129, v129
    v_smfmac_f32_32x32x32_bf16 v[152:167], v[184:187], v[120:127], v18
    ds_read_b128 v[216:219], v6 offset:2048
    ds_read_b128 v[220:223], v6 offset:3072
    buffer_load_dwordx4 v78, s[16:19], s59 offen lds
    v_exp_f32 v130, v130
    v_exp_f32 v131, v131
    v_exp_f32 v132, v132
    v_exp_f32 v133, v133
    s_waitcnt lgkmcnt(2)
    v_mfma_f32_32x32x16_bf16 v[104:119], v[200:203], v[96:99], 0
    s_mov_b32 s52, 229376
    buffer_load_dwordx4 v[40:43], v8, s[36:39], s52 offen
    v_exp_f32 v134, v134
    v_exp_f32 v135, v135
    v_exp_f32 v136, v136
    v_exp_f32 v137, v137
    v_smfmac_f32_32x32x32_bf16 v[152:167], v[188:191], v[128:135], v18
    v_exp_f32 v138, v138
    v_exp_f32 v139, v139
    v_exp_f32 v140, v140
    v_exp_f32 v141, v141
    v_mfma_f32_32x32x16_bf16 v[104:119], v[204:207], v[100:103], v[104:119]
    ds_read_b128 v[224:227], v6 offset:6144
    ds_read_b128 v[228:231], v6 offset:7168
    v_exp_f32 v142, v142
    v_exp_f32 v143, v143
    v_exp_f32 v144, v144
    v_exp_f32 v145, v145
    v_smfmac_f32_32x32x32_bf16 v[152:167], v[192:195], v[136:143], v18
    v_exp_f32 v146, v146
    v_exp_f32 v147, v147
    v_exp_f32 v148, v148
    v_exp_f32 v149, v149
    v_mfma_f32_32x32x16_bf16 v[120:135], v[208:211], v[96:99], 0
    v_exp_f32 v150, v150
    v_exp_f32 v151, v151
    s_waitcnt vmcnt(11) lgkmcnt(0)
    s_barrier
    ds_read_b128 v[168:171], v6 offset:16384
    ds_read_b128 v[172:175], v6 offset:17408
    v_exp_f32 v104, v104
    s_mov_b32 m0, s56
    s_xor_b32 s51, s58, 212992
    v_exp_f32 v105, v105
    v_smfmac_f32_32x32x32_bf16 v[152:167], v[196:199], v[144:151], v18
    buffer_load_dwordx4 v5, s[20:23], s51 offen offset:0 sc1 lds
    v_exp_f32 v106, v106
    v_exp_f32 v107, v107
    v_exp_f32 v108, v108
    v_exp_f32 v109, v109
    v_mfma_f32_32x32x16_bf16 v[120:135], v[212:215], v[100:103], v[120:135]
    ds_read_b128 v[176:179], v6 offset:20480
    ds_read_b128 v[180:183], v6 offset:21504
    buffer_load_dwordx4 v5, s[20:23], s51 offen offset:1024 sc1 lds
    v_exp_f32 v110, v110
    v_exp_f32 v111, v111
    v_exp_f32 v112, v112
    s_add_u32 m0, s57, 57344
    s_mov_b32 s59, 229376
    v_exp_f32 v113, v113
    v_smfmac_f32_32x32x32_bf16 v[152:167], v[216:219], v[104:111], v18
    ds_read_b128 v[184:187], v6 offset:18432
    ds_read_b128 v[188:191], v6 offset:19456
    buffer_load_dwordx4 v78, s[16:19], s59 offen lds
    v_exp_f32 v114, v114
    v_exp_f32 v115, v115
    v_exp_f32 v116, v116
    v_exp_f32 v117, v117
    s_waitcnt lgkmcnt(2)
    v_mfma_f32_32x32x16_bf16 v[136:151], v[168:171], v[96:99], 0
    s_mov_b32 s52, 286720
    buffer_load_dwordx4 v[44:47], v8, s[36:39], s52 offen
    v_exp_f32 v118, v118
    v_exp_f32 v119, v119
    v_exp_f32 v120, v120
    v_exp_f32 v121, v121
    v_smfmac_f32_32x32x32_bf16 v[152:167], v[220:223], v[112:119], v18
    v_exp_f32 v122, v122
    v_exp_f32 v123, v123
    v_exp_f32 v124, v124
    v_exp_f32 v125, v125
    v_mfma_f32_32x32x16_bf16 v[136:151], v[172:175], v[100:103], v[136:151]
    ds_read_b128 v[192:195], v6 offset:22528
    ds_read_b128 v[196:199], v6 offset:23552
    v_exp_f32 v126, v126
    v_exp_f32 v127, v127
    v_exp_f32 v128, v128
    v_exp_f32 v129, v129
    v_smfmac_f32_32x32x32_bf16 v[152:167], v[224:227], v[120:127], v18
    v_exp_f32 v130, v130
    v_exp_f32 v131, v131
    v_exp_f32 v132, v132
    v_exp_f32 v133, v133
    v_mfma_f32_32x32x16_bf16 v[104:119], v[176:179], v[96:99], 0
    v_exp_f32 v134, v134
    v_exp_f32 v135, v135
    s_waitcnt vmcnt(11) lgkmcnt(0)
    s_barrier
    ds_read_b128 v[200:203], v6 offset:32768
    ds_read_b128 v[204:207], v6 offset:33792
    v_exp_f32 v136, v136
    s_add_u32 m0, s56, 16384
    s_xor_b32 s51, s58, 229376
    v_exp_f32 v137, v137
    v_smfmac_f32_32x32x32_bf16 v[152:167], v[228:231], v[128:135], v18
    buffer_load_dwordx4 v5, s[20:23], s51 offen offset:0 sc1 lds
    v_exp_f32 v138, v138
    v_exp_f32 v139, v139
    v_exp_f32 v140, v140
    v_exp_f32 v141, v141
    v_mfma_f32_32x32x16_bf16 v[104:119], v[180:183], v[100:103], v[104:119]
    ds_read_b128 v[208:211], v6 offset:36864
    ds_read_b128 v[212:215], v6 offset:37888
    buffer_load_dwordx4 v5, s[20:23], s51 offen offset:1024 sc1 lds
    v_exp_f32 v142, v142
    v_exp_f32 v143, v143
    v_exp_f32 v144, v144
    s_add_u32 m0, s57, 64512
    s_mov_b32 s59, 258048
    v_exp_f32 v145, v145
    v_smfmac_f32_32x32x32_bf16 v[152:167], v[184:187], v[136:143], v18
    ds_read_b128 v[216:219], v6 offset:34816
    ds_read_b128 v[220:223], v6 offset:35840
    buffer_load_dwordx4 v78, s[16:19], s59 offen lds
    v_exp_f32 v146, v146
    v_exp_f32 v147, v147
    v_exp_f32 v148, v148
    v_exp_f32 v149, v149
    s_waitcnt lgkmcnt(2)
    v_mfma_f32_32x32x16_bf16 v[120:135], v[200:203], v[96:99], 0
    s_mov_b32 s52, 344064
    buffer_load_dwordx4 v[48:51], v8, s[36:39], s52 offen
    v_exp_f32 v150, v150
    v_exp_f32 v151, v151
    v_exp_f32 v104, v104
    v_exp_f32 v105, v105
    v_smfmac_f32_32x32x32_bf16 v[152:167], v[188:191], v[144:151], v18
    s_mul_i32 s52, s47, 28672
    buffer_load_dwordx4 v[52:55], v7, s[4:7], s52 offen
    v_exp_f32 v106, v106
    v_exp_f32 v107, v107
    v_exp_f32 v108, v108
    v_exp_f32 v109, v109
    v_mfma_f32_32x32x16_bf16 v[120:135], v[204:207], v[100:103], v[120:135]
    ds_read_b128 v[224:227], v6 offset:38912
    ds_read_b128 v[228:231], v6 offset:39936
    v_exp_f32 v110, v110
    v_exp_f32 v111, v111
    v_exp_f32 v112, v112
    v_exp_f32 v113, v113
    v_smfmac_f32_32x32x32_bf16 v[152:167], v[192:195], v[104:111], v18
    v_exp_f32 v114, v114
    v_exp_f32 v115, v115
    v_exp_f32 v116, v116
    v_exp_f32 v117, v117
    v_mfma_f32_32x32x16_bf16 v[136:151], v[208:211], v[96:99], 0
    v_exp_f32 v118, v118
    v_exp_f32 v119, v119
    s_waitcnt vmcnt(11) lgkmcnt(0)
    s_barrier
    ds_read_b128 v[168:171], v6 offset:49152
    ds_read_b128 v[172:175], v6 offset:50176
    v_exp_f32 v120, v120
    s_add_u32 m0, s56, 32768
    s_xor_b32 s51, s58, 245760
    v_exp_f32 v121, v121
    v_smfmac_f32_32x32x32_bf16 v[152:167], v[196:199], v[112:119], v18
    buffer_load_dwordx4 v5, s[20:23], s51 offen offset:0 sc1 lds
    v_exp_f32 v122, v122
    v_exp_f32 v123, v123
    v_exp_f32 v124, v124
    v_exp_f32 v125, v125
    v_mfma_f32_32x32x16_bf16 v[136:151], v[212:215], v[100:103], v[136:151]
    ds_read_b128 v[176:179], v6 offset:53248
    ds_read_b128 v[180:183], v6 offset:54272
    buffer_load_dwordx4 v5, s[20:23], s51 offen offset:1024 sc1 lds
    v_exp_f32 v126, v126
    v_exp_f32 v127, v127
    v_exp_f32 v128, v128
    s_add_u32 m0, s57, 71680
    s_mov_b32 s59, 286720
    v_exp_f32 v129, v129
    v_smfmac_f32_32x32x32_bf16 v[152:167], v[216:219], v[120:127], v18
    ds_read_b128 v[184:187], v6 offset:51200
    ds_read_b128 v[188:191], v6 offset:52224
    buffer_load_dwordx4 v78, s[16:19], s59 offen lds
    v_exp_f32 v130, v130
    v_exp_f32 v131, v131
    v_exp_f32 v132, v132
    s_add_u32 m0, s57, 78848
    s_mov_b32 s59, 315392
    v_exp_f32 v133, v133
    s_waitcnt lgkmcnt(2)
    v_mfma_f32_32x32x16_bf16 v[104:119], v[168:171], v[96:99], 0
    buffer_load_dwordx4 v78, s[16:19], s59 offen lds
    v_exp_f32 v134, v134
    v_exp_f32 v135, v135
    v_exp_f32 v136, v136
    v_exp_f32 v137, v137
    v_smfmac_f32_32x32x32_bf16 v[152:167], v[220:223], v[128:135], v18
    buffer_load_dwordx4 v[80:83], v2, s[8:11], s73 offen offset:0
    v_exp_f32 v138, v138
    v_exp_f32 v139, v139
    v_exp_f32 v140, v140
    v_exp_f32 v141, v141
    v_mfma_f32_32x32x16_bf16 v[104:119], v[172:175], v[100:103], v[104:119]
    ds_read_b128 v[192:195], v6 offset:55296
    ds_read_b128 v[196:199], v6 offset:56320
    buffer_load_dwordx2 v[56:57], v17, s[32:35], 0 offen
    buffer_load_dwordx4 v[60:63], v2, s[32:35], 0 offen
    v_exp_f32 v142, v142
    v_exp_f32 v143, v143
    v_exp_f32 v144, v144
    v_exp_f32 v145, v145
    v_smfmac_f32_32x32x32_bf16 v[152:167], v[224:227], v[136:143], v18
    v_exp_f32 v146, v146
    v_exp_f32 v147, v147
    v_exp_f32 v148, v148
    v_exp_f32 v149, v149
    v_mfma_f32_32x32x16_bf16 v[120:135], v[176:179], v[96:99], 0
    v_exp_f32 v150, v150
    v_exp_f32 v151, v151
    s_waitcnt vmcnt(14) lgkmcnt(0)
    s_barrier
    ds_read_b128 v[200:203], v6 offset:0
    ds_read_b128 v[204:207], v6 offset:1024
    v_exp_f32 v104, v104
    s_add_u32 m0, s57, 86016
    s_mov_b32 s59, 344064
    v_exp_f32 v105, v105
    v_smfmac_f32_32x32x32_bf16 v[152:167], v[228:231], v[144:151], v18
    buffer_load_dwordx4 v78, s[16:19], s59 offen lds
    v_exp_f32 v106, v106
    v_exp_f32 v107, v107
    v_exp_f32 v108, v108
    v_exp_f32 v109, v109
    v_mfma_f32_32x32x16_bf16 v[120:135], v[180:183], v[100:103], v[120:135]
    ds_read_b128 v[208:211], v6 offset:4096
    ds_read_b128 v[212:215], v6 offset:5120
    buffer_load_dwordx4 v[84:87], v2, s[8:11], s73 offen offset:896
    v_exp_f32 v110, v110
    v_exp_f32 v111, v111
    v_exp_f32 v112, v112
    v_exp_f32 v113, v113
    v_smfmac_f32_32x32x32_bf16 v[152:167], v[184:187], v[104:111], v18
    ds_read_b128 v[216:219], v6 offset:2048
    ds_read_b128 v[220:223], v6 offset:3072
    s_mov_b32 s52, 8388612
    buffer_load_dword v70, v16, s[20:23], s52 offen sc1
    v_exp_f32 v114, v114
    v_exp_f32 v115, v115
    v_exp_f32 v116, v116
    v_exp_f32 v117, v117
    s_waitcnt lgkmcnt(2)
    v_mfma_f32_32x32x16_bf16 v[136:151], v[200:203], v[96:99], 0
    v_exp_f32 v118, v118
    v_exp_f32 v119, v119
    v_exp_f32 v120, v120
    v_exp_f32 v121, v121
    v_smfmac_f32_32x32x32_bf16 v[152:167], v[188:191], v[112:119], v18
    v_exp_f32 v122, v122
    v_exp_f32 v123, v123
    v_exp_f32 v124, v124
    v_exp_f32 v125, v125
    v_mfma_f32_32x32x16_bf16 v[136:151], v[204:207], v[100:103], v[136:151]
    ds_read_b128 v[224:227], v6 offset:6144
    ds_read_b128 v[228:231], v6 offset:7168
    v_exp_f32 v126, v126
    v_exp_f32 v127, v127
    v_exp_f32 v128, v128
    v_exp_f32 v129, v129
    v_smfmac_f32_32x32x32_bf16 v[152:167], v[192:195], v[120:127], v18
    v_exp_f32 v130, v130
    v_exp_f32 v131, v131
    v_exp_f32 v132, v132
    v_exp_f32 v133, v133
    v_mfma_f32_32x32x16_bf16 v[104:119], v[208:211], v[96:99], 0
    v_exp_f32 v134, v134
    v_exp_f32 v135, v135
    s_waitcnt vmcnt(13) lgkmcnt(0)
    s_barrier
    ds_read_b128 v[168:171], v6 offset:16384
    ds_read_b128 v[172:175], v6 offset:17408
    v_exp_f32 v136, v136
    s_add_u32 m0, s57, 93184
    s_mov_b32 s59, 372736
    v_exp_f32 v137, v137
    v_smfmac_f32_32x32x32_bf16 v[152:167], v[196:199], v[128:135], v18
    buffer_load_dwordx4 v78, s[16:19], s59 offen lds
    v_exp_f32 v138, v138
    v_exp_f32 v139, v139
    v_exp_f32 v140, v140
    v_exp_f32 v141, v141
    v_mfma_f32_32x32x16_bf16 v[104:119], v[212:215], v[100:103], v[104:119]
    ds_read_b128 v[176:179], v6 offset:20480
    ds_read_b128 v[180:183], v6 offset:21504
    buffer_load_dwordx4 v[88:91], v2, s[8:11], s73 offen offset:1792
    v_exp_f32 v142, v142
    v_exp_f32 v143, v143
    v_exp_f32 v144, v144
    v_exp_f32 v145, v145
    v_smfmac_f32_32x32x32_bf16 v[152:167], v[216:219], v[136:143], v18
    ds_read_b128 v[184:187], v6 offset:18432
    ds_read_b128 v[188:191], v6 offset:19456
    v_exp_f32 v146, v146
    v_exp_f32 v147, v147
    v_exp_f32 v148, v148
    v_exp_f32 v149, v149
    s_waitcnt lgkmcnt(2)
    v_mfma_f32_32x32x16_bf16 v[120:135], v[168:171], v[96:99], 0
    v_exp_f32 v150, v150
    v_exp_f32 v151, v151
    v_exp_f32 v104, v104
    v_exp_f32 v105, v105
    v_smfmac_f32_32x32x32_bf16 v[152:167], v[220:223], v[144:151], v18
    v_exp_f32 v106, v106
    v_exp_f32 v107, v107
    v_exp_f32 v108, v108
    v_exp_f32 v109, v109
    v_mfma_f32_32x32x16_bf16 v[120:135], v[172:175], v[100:103], v[120:135]
    ds_read_b128 v[192:195], v6 offset:22528
    ds_read_b128 v[196:199], v6 offset:23552
    v_exp_f32 v110, v110
    v_exp_f32 v111, v111
    v_exp_f32 v112, v112
    v_exp_f32 v113, v113
    v_smfmac_f32_32x32x32_bf16 v[152:167], v[224:227], v[104:111], v18
    v_exp_f32 v114, v114
    v_exp_f32 v115, v115
    v_exp_f32 v116, v116
    v_exp_f32 v117, v117
    v_mfma_f32_32x32x16_bf16 v[136:151], v[176:179], v[96:99], 0
    v_exp_f32 v118, v118
    v_exp_f32 v119, v119
    s_waitcnt vmcnt(10) lgkmcnt(0)
    s_barrier
    ds_read_b128 v[200:203], v6 offset:32768
    ds_read_b128 v[204:207], v6 offset:33792
    v_exp_f32 v120, v120
    s_mov_b32 m0, s57
    s_mov_b32 s59, 0
    v_exp_f32 v121, v121
    v_smfmac_f32_32x32x32_bf16 v[152:167], v[228:231], v[112:119], v18
    buffer_load_dwordx4 v78, s[16:19], s59 offen lds
    v_exp_f32 v122, v122
    v_exp_f32 v123, v123
    v_exp_f32 v124, v124
    v_exp_f32 v125, v125
    v_mfma_f32_32x32x16_bf16 v[136:151], v[180:183], v[100:103], v[136:151]
    ds_read_b128 v[208:211], v6 offset:36864
    ds_read_b128 v[212:215], v6 offset:37888
    buffer_load_dwordx4 v[92:95], v2, s[8:11], s73 offen offset:2688
    v_exp_f32 v126, v126
    v_exp_f32 v127, v127
    v_exp_f32 v128, v128
    v_exp_f32 v129, v129
    v_smfmac_f32_32x32x32_bf16 v[152:167], v[184:187], v[120:127], v18
    ds_read_b128 v[216:219], v6 offset:34816
    ds_read_b128 v[220:223], v6 offset:35840
    v_exp_f32 v130, v130
    v_exp_f32 v131, v131
    v_exp_f32 v132, v132
    v_exp_f32 v133, v133
    s_waitcnt lgkmcnt(2)
    v_mfma_f32_32x32x16_bf16 v[104:119], v[200:203], v[96:99], 0
    v_exp_f32 v134, v134
    v_exp_f32 v135, v135
    v_exp_f32 v136, v136
    v_exp_f32 v137, v137
    v_smfmac_f32_32x32x32_bf16 v[152:167], v[188:191], v[128:135], v18
    v_exp_f32 v138, v138
    v_exp_f32 v139, v139
    v_exp_f32 v140, v140
    v_exp_f32 v141, v141
    v_mfma_f32_32x32x16_bf16 v[104:119], v[204:207], v[100:103], v[104:119]
    ds_read_b128 v[224:227], v6 offset:38912
    ds_read_b128 v[228:231], v6 offset:39936
    v_exp_f32 v142, v142
    v_exp_f32 v143, v143
    v_exp_f32 v144, v144
    v_exp_f32 v145, v145
    v_smfmac_f32_32x32x32_bf16 v[152:167], v[192:195], v[136:143], v18
    v_exp_f32 v146, v146
    v_exp_f32 v147, v147
    v_exp_f32 v148, v148
    v_exp_f32 v149, v149
    v_mfma_f32_32x32x16_bf16 v[120:135], v[208:211], v[96:99], 0
    v_exp_f32 v150, v150
    v_exp_f32 v151, v151
    s_waitcnt lgkmcnt(0)
    s_barrier
    v_exp_f32 v104, v104
    v_exp_f32 v105, v105
    v_smfmac_f32_32x32x32_bf16 v[152:167], v[196:199], v[144:151], v18
    s_waitcnt vmcnt(4)
    v_cmp_gt_u32 vcc, 16, v70
    s_and_b32 vcc_lo, vcc_lo, 0xffff
    s_cbranch_scc1 L_23
L_24:
    v_exp_f32 v106, v106
    v_exp_f32 v107, v107
    v_exp_f32 v108, v108
    v_exp_f32 v109, v109
    v_mfma_f32_32x32x16_bf16 v[120:135], v[212:215], v[100:103], v[120:135]
    v_exp_f32 v110, v110
    v_exp_f32 v111, v111
    v_exp_f32 v112, v112
    v_exp_f32 v113, v113
    v_smfmac_f32_32x32x32_bf16 v[152:167], v[216:219], v[104:111], v18
    v_exp_f32 v114, v114
    v_exp_f32 v115, v115
    v_exp_f32 v116, v116
    v_exp_f32 v117, v117
    v_exp_f32 v118, v118
    v_exp_f32 v119, v119
    s_nop 0
    v_exp_f32 v120, v120
    v_exp_f32 v121, v121
    v_smfmac_f32_32x32x32_bf16 v[152:167], v[220:223], v[112:119], v18
    v_exp_f32 v122, v122
    v_exp_f32 v123, v123
    v_exp_f32 v124, v124
    v_exp_f32 v125, v125
    v_exp_f32 v126, v126
    v_exp_f32 v127, v127
    v_exp_f32 v128, v128
    v_exp_f32 v129, v129
    v_smfmac_f32_32x32x32_bf16 v[152:167], v[224:227], v[120:127], v18
    v_exp_f32 v130, v130
    v_exp_f32 v131, v131
    v_exp_f32 v132, v132
    v_exp_f32 v133, v133
    v_exp_f32 v134, v134
    v_exp_f32 v135, v135
    s_branch L_tail1
    .fill 15, 4, 0xbf810000
L_loop1:
    s_waitcnt vmcnt(4) lgkmcnt(0)
    s_barrier
    ds_read_b128 v[200:203], v6 offset:0
    ds_read_b128 v[204:207], v6 offset:1024
    v_exp_f32 v104, v104
    v_exp_f32 v105, v105
    s_and_b32 s54, s81, 7
    s_lshr_b32 s53, s81, 3
    s_sub_u32 s53, s53, 7
    s_mov_b32 s15, 0x20000
    s_mov_b32 s14, 1605632
    s_cmp_ge_u32 s40, 6
    s_cbranch_scc1 L_25
    s_cmp_eq_u32 s40, 4
    s_cselect_b32 s12, s76, s78
    s_cselect_b32 s13, s77, s79
    v_min_u32 v10, 29, v1
    v_mul_u32_u24 v11, 52, v10
    v_lshrrev_b32 v11, 8, v11
    v_mul_u32_u24 v12, 5, v11
    v_sub_u32 v12, v10, v12
    v_lshlrev_b32 v12, 7, v12
    v_min_u32 v12, 444, v12
    v_mul_u32_u24 v11, 3584, v11
    v_add_u32 v79, v11, v12
    s_mul_i32 s75, s53, 64512
    s_mul_i32 s54, s54, 448
    s_add_u32 s75, s75, s54
    s_mov_b32 s74, 21504
    s_branch L_26
L_25:
    s_mul_i32 s75, s54, 25
    s_add_u32 s75, s75, s53
    s_lshl_b32 s75, s75, 11
    s_mul_i32 s54, s54, 200704
    s_mul_i32 s53, s53, 8064
    s_add_u32 s54, s54, s53
    s_cmp_eq_u32 s40, 6
    s_cselect_b32 s12, s82, s16
    s_cselect_b32 s13, s83, s17
    s_cselect_b32 s14, s14, 401408
    s_cselect_b32 s75, s54, s75
    s_cselect_b32 s53, 20, 5
    v_min_u32 v79, s53, v1
    v_lshlrev_b32 v79, 7, v79
    s_add_u32 s74, s53, 1
    s_lshl_b32 s74, s74, 7
L_26:
    buffer_load_dword v9, v79, s[12:15], s75 offen
    v_exp_f32 v106, v106
    v_exp_f32 v107, v107
    v_exp_f32 v108, v108
    v_exp_f32 v109, v109
    v_mfma_f32_32x32x16_bf16 v[120:135], v[180:183], v[100:103], v[120:135]
    ds_read_b128 v[208:211], v6 offset:4096
    ds_read_b128 v[212:215], v6 offset:5120
    v_exp_f32 v110, v110
    v_exp_f32 v111, v111
    v_exp_f32 v112, v112
    v_exp_f32 v113, v113
    v_smfmac_f32_32x32x32_bf16 v[152:167], v[184:187], v[104:111], v18
    ds_read_b128 v[216:219], v6 offset:2048
    ds_read_b128 v[220:223], v6 offset:3072
    v_exp_f32 v114, v114
    v_exp_f32 v115, v115
    v_exp_f32 v116, v116
    v_exp_f32 v117, v117
    s_waitcnt lgkmcnt(2)
    v_mfma_f32_32x32x16_bf16 v[136:151], v[200:203], v[96:99], 0
    v_exp_f32 v118, v118
    v_exp_f32 v119, v119
    v_exp_f32 v120, v120
    v_exp_f32 v121, v121
    v_smfmac_f32_32x32x32_bf16 v[152:167], v[188:191], v[112:119], v18
    v_exp_f32 v122, v122
    v_exp_f32 v123, v123
    v_exp_f32 v124, v124
    v_exp_f32 v125, v125
    v_mfma_f32_32x32x16_bf16 v[136:151], v[204:207], v[100:103], v[136:151]
    ds_read_b128 v[224:227], v6 offset:6144
    ds_read_b128 v[228:231], v6 offset:7168
    v_exp_f32 v126, v126
    v_exp_f32 v127, v127
    v_exp_f32 v128, v128
    v_exp_f32 v129, v129
    v_smfmac_f32_32x32x32_bf16 v[152:167], v[192:195], v[120:127], v18
    v_exp_f32 v130, v130
    v_exp_f32 v131, v131
    v_exp_f32 v132, v132
    v_exp_f32 v133, v133
    v_mfma_f32_32x32x16_bf16 v[104:119], v[208:211], v[96:99], 0
    v_exp_f32 v134, v134
    v_exp_f32 v135, v135
    s_waitcnt vmcnt(3) lgkmcnt(0)
    s_barrier
    ds_read_b128 v[168:171], v6 offset:16384
    ds_read_b128 v[172:175], v6 offset:17408
    v_exp_f32 v136, v136
    v_exp_f32 v137, v137
    v_smfmac_f32_32x32x32_bf16 v[152:167], v[196:199], v[128:135], v18
    s_add_u32 s52, s40, s63
    s_cmp_lg_u32 s52, 0
    s_cbranch_scc1 L_27
    s_lshl_b32 s52, s43, 10
    s_add_u32 s52, s52, 8388612
    s_mov_b64 exec, 1
    v_mov_b32 v10, 1
    buffer_atomic_add v10, v2, s[20:23], s52 offen sc1
    s_mov_b64 exec, -1
L_27:
    v_exp_f32 v138, v138
    v_exp_f32 v139, v139
    v_exp_f32 v140, v140
    v_exp_f32 v141, v141
    v_mfma_f32_32x32x16_bf16 v[104:119], v[212:215], v[100:103], v[104:119]
    ds_read_b128 v[176:179], v6 offset:20480
    ds_read_b128 v[180:183], v6 offset:21504
    s_add_u32 s75, s75, s74
    buffer_load_dword v9, v79, s[12:15], s75 offen
    v_exp_f32 v142, v142
    v_exp_f32 v143, v143
    v_exp_f32 v144, v144
    v_exp_f32 v145, v145
    v_smfmac_f32_32x32x32_bf16 v[152:167], v[216:219], v[136:143], v18
    ds_read_b128 v[184:187], v6 offset:18432
    ds_read_b128 v[188:191], v6 offset:19456
    v_exp_f32 v146, v146
    v_exp_f32 v147, v147
    v_exp_f32 v148, v148
    v_exp_f32 v149, v149
    s_waitcnt lgkmcnt(2)
    v_mfma_f32_32x32x16_bf16 v[120:135], v[168:171], v[96:99], 0
    v_exp_f32 v150, v150
    v_exp_f32 v151, v151
    v_exp_f32 v104, v104
    v_exp_f32 v105, v105
    v_smfmac_f32_32x32x32_bf16 v[152:167], v[220:223], v[144:151], v18
    v_exp_f32 v106, v106
    v_exp_f32 v107, v107
    v_exp_f32 v108, v108
    v_exp_f32 v109, v109
    v_mfma_f32_32x32x16_bf16 v[120:135], v[172:175], v[100:103], v[120:135]
    ds_read_b128 v[192:195], v6 offset:22528
    ds_read_b128 v[196:199], v6 offset:23552
    v_exp_f32 v110, v110
    v_exp_f32 v111, v111
    v_exp_f32 v112, v112
    v_exp_f32 v113, v113
    v_smfmac_f32_32x32x32_bf16 v[152:167], v[224:227], v[104:111], v18
    v_exp_f32 v114, v114
    v_exp_f32 v115, v115
    v_exp_f32 v116, v116
    v_exp_f32 v117, v117
    v_mfma_f32_32x32x16_bf16 v[136:151], v[176:179], v[96:99], 0
    v_exp_f32 v118, v118
    v_exp_f32 v119, v119
    s_waitcnt vmcnt(2) lgkmcnt(0)
    s_barrier
    ds_read_b128 v[200:203], v6 offset:32768
    ds_read_b128 v[204:207], v6 offset:33792
    v_exp_f32 v120, v120
    v_exp_f32 v121, v121
    v_smfmac_f32_32x32x32_bf16 v[152:167], v[228:231], v[112:119], v18
    s_add_u32 s75, s75, s74
    buffer_load_dword v9, v79, s[12:15], s75 offen
    v_exp_f32 v122, v122
    v_exp_f32 v123, v123
    v_exp_f32 v124, v124
    v_exp_f32 v125, v125
    v_mfma_f32_32x32x16_bf16 v[136:151], v[180:183], v[100:103], v[136:151]
    ds_read_b128 v[208:211], v6 offset:36864
    ds_read_b128 v[212:215], v6 offset:37888
    v_exp_f32 v126, v126
    v_exp_f32 v127, v127
    v_exp_f32 v128, v128
    v_exp_f32 v129, v129
    v_smfmac_f32_32x32x32_bf16 v[152:167], v[184:187], v[120:127], v18
    ds_read_b128 v[216:219], v6 offset:34816
    ds_read_b128 v[220:223], v6 offset:35840
    v_exp_f32 v130, v130
    v_exp_f32 v131, v131
    v_exp_f32 v132, v132
    v_exp_f32 v133, v133
    s_waitcnt lgkmcnt(2)
    v_mfma_f32_32x32x16_bf16 v[104:119], v[200:203], v[96:99], 0
    v_exp_f32 v134, v134
    v_exp_f32 v135, v135
    v_exp_f32 v136, v136
    v_exp_f32 v137, v137
    v_smfmac_f32_32x32x32_bf16 v[152:167], v[188:191], v[128:135], v18
    v_exp_f32 v138, v138
    v_exp_f32 v139, v139
    v_exp_f32 v140, v140
    v_exp_f32 v141, v141
    v_mfma_f32_32x32x16_bf16 v[104:119], v[204:207], v[100:103], v[104:119]
    ds_read_b128 v[224:227], v6 offset:38912
    ds_read_b128 v[228:231], v6 offset:39936
    v_exp_f32 v142, v142
    v_exp_f32 v143, v143
    v_exp_f32 v144, v144
    v_exp_f32 v145, v145
    v_smfmac_f32_32x32x32_bf16 v[152:167], v[192:195], v[136:143], v18
    v_exp_f32 v146, v146
    v_exp_f32 v147, v147
    v_exp_f32 v148, v148
    v_exp_f32 v149, v149
    v_mfma_f32_32x32x16_bf16 v[120:135], v[208:211], v[96:99], 0
    v_exp_f32 v150, v150
    v_exp_f32 v151, v151
    s_waitcnt lgkmcnt(0)
    s_barrier
    ds_read_b128 v[168:171], v6 offset:49152
    ds_read_b128 v[172:175], v6 offset:50176
    v_exp_f32 v104, v104
    v_exp_f32 v105, v105
    v_smfmac_f32_32x32x32_bf16 v[152:167], v[196:199], v[144:151], v18
    v_exp_f32 v106, v106
    v_exp_f32 v107, v107
    v_exp_f32 v108, v108
    v_exp_f32 v109, v109
    v_mfma_f32_32x32x16_bf16 v[120:135], v[212:215], v[100:103], v[120:135]
    ds_read_b128 v[176:179], v6 offset:53248
    ds_read_b128 v[180:183], v6 offset:54272
    v_exp_f32 v110, v110
    v_exp_f32 v111, v111
    v_exp_f32 v112, v112
    v_exp_f32 v113, v113
    v_smfmac_f32_32x32x32_bf16 v[152:167], v[216:219], v[104:111], v18
    ds_read_b128 v[184:187], v6 offset:51200
    ds_read_b128 v[188:191], v6 offset:52224
    v_exp_f32 v114, v114
    v_exp_f32 v115, v115
    v_exp_f32 v116, v116
    v_exp_f32 v117, v117
    s_waitcnt lgkmcnt(2)
    v_mfma_f32_32x32x16_bf16 v[136:151], v[168:171], v[96:99], 0
    v_exp_f32 v118, v118
    v_exp_f32 v119, v119
    v_exp_f32 v120, v120
    v_exp_f32 v121, v121
    v_smfmac_f32_32x32x32_bf16 v[152:167], v[220:223], v[112:119], v18
    v_exp_f32 v122, v122
    v_exp_f32 v123, v123
    v_exp_f32 v124, v124
    v_exp_f32 v125, v125
    v_mfma_f32_32x32x16_bf16 v[136:151], v[172:175], v[100:103], v[136:151]
    ds_read_b128 v[192:195], v6 offset:55296
    ds_read_b128 v[196:199], v6 offset:56320
    v_exp_f32 v126, v126
    v_exp_f32 v127, v127
    v_exp_f32 v128, v128
    v_exp_f32 v129, v129
    v_smfmac_f32_32x32x32_bf16 v[152:167], v[224:227], v[120:127], v18
    v_exp_f32 v130, v130
    v_exp_f32 v131, v131
    v_exp_f32 v132, v132
    v_exp_f32 v133, v133
    v_mfma_f32_32x32x16_bf16 v[104:119], v[176:179], v[96:99], 0
    v_exp_f32 v134, v134
    v_exp_f32 v135, v135
    s_waitcnt lgkmcnt(0)
    s_barrier
    ds_read_b128 v[200:203], v6 offset:0
    ds_read_b128 v[204:207], v6 offset:1024
    v_exp_f32 v136, v136
    s_add_u32 m0, s57, 7168
    s_mov_b32 s59, 28672
    v_exp_f32 v137, v137
    v_smfmac_f32_32x32x32_bf16 v[152:167], v[228:231], v[128:135], v18
    buffer_load_dwordx4 v78, s[16:19], s59 offen lds
    v_exp_f32 v138, v138
    v_exp_f32 v139, v139
    v_exp_f32 v140, v140
    s_add_u32 m0, s57, 14336
    s_mov_b32 s59, 57344
    v_exp_f32 v141, v141
    v_mfma_f32_32x32x16_bf16 v[104:119], v[180:183], v[100:103], v[104:119]
    ds_read_b128 v[208:211], v6 offset:4096
    ds_read_b128 v[212:215], v6 offset:5120
    buffer_load_dwordx4 v78, s[16:19], s59 offen lds
    v_exp_f32 v142, v142
    v_exp_f32 v143, v143
    v_exp_f32 v144, v144
    v_exp_f32 v145, v145
    v_smfmac_f32_32x32x32_bf16 v[152:167], v[184:187], v[136:143], v18
    ds_read_b128 v[216:219], v6 offset:2048
    ds_read_b128 v[220:223], v6 offset:3072
    v_exp_f32 v146, v146
    v_exp_f32 v147, v147
    v_exp_f32 v148, v148
    v_exp_f32 v149, v149
    s_waitcnt lgkmcnt(2)
    v_mfma_f32_32x32x16_bf16 v[120:135], v[200:203], v[96:99], 0
    v_exp_f32 v150, v150
    v_exp_f32 v151, v151
    v_exp_f32 v104, v104
    v_exp_f32 v105, v105
    v_smfmac_f32_32x32x32_bf16 v[152:167], v[188:191], v[144:151], v18
    v_exp_f32 v106, v106
    v_exp_f32 v107, v107
    v_exp_f32 v108, v108
    v_exp_f32 v109, v109
    v_mfma_f32_32x32x16_bf16 v[120:135], v[204:207], v[100:103], v[120:135]
    ds_read_b128 v[224:227], v6 offset:6144
    ds_read_b128 v[228:231], v6 offset:7168
    v_exp_f32 v110, v110
    v_exp_f32 v111, v111
    v_exp_f32 v112, v112
    v_exp_f32 v113, v113
    v_smfmac_f32_32x32x32_bf16 v[152:167], v[192:195], v[104:111], v18
    v_exp_f32 v114, v114
    v_exp_f32 v115, v115
    v_exp_f32 v116, v116
    v_exp_f32 v117, v117
    v_mfma_f32_32x32x16_bf16 v[136:151], v[208:211], v[96:99], 0
    v_exp_f32 v118, v118
    v_exp_f32 v119, v119
    s_waitcnt lgkmcnt(0)
    s_barrier
    ds_read_b128 v[168:171], v6 offset:16384
    ds_read_b128 v[172:175], v6 offset:17408
    v_exp_f32 v120, v120
    s_mov_b32 m0, s56
    s_xor_b32 s51, s58, 147456
    v_exp_f32 v121, v121
    v_smfmac_f32_32x32x32_bf16 v[152:167], v[196:199], v[112:119], v18
    buffer_load_dwordx4 v5, s[20:23], s51 offen offset:0 sc1 lds
    v_exp_f32 v122, v122
    v_exp_f32 v123, v123
    v_exp_f32 v124, v124
    v_exp_f32 v125, v125
    v_mfma_f32_32x32x16_bf16 v[136:151], v[212:215], v[100:103], v[136:151]
    ds_read_b128 v[176:179], v6 offset:20480
    ds_read_b128 v[180:183], v6 offset:21504
    buffer_load_dwordx4 v5, s[20:23], s51 offen offset:1024 sc1 lds
    v_exp_f32 v126, v126
    v_exp_f32 v127, v127
    v_exp_f32 v128, v128
    s_add_u32 m0, s57, 21504
    s_mov_b32 s59, 86016
    v_exp_f32 v129, v129
    v_smfmac_f32_32x32x32_bf16 v[152:167], v[216:219], v[120:127], v18
    ds_read_b128 v[184:187], v6 offset:18432
    ds_read_b128 v[188:191], v6 offset:19456
    buffer_load_dwordx4 v78, s[16:19], s59 offen lds
    v_exp_f32 v130, v130
    v_exp_f32 v131, v131
    v_exp_f32 v132, v132
    v_exp_f32 v133, v133
    s_waitcnt lgkmcnt(2)
    v_mfma_f32_32x32x16_bf16 v[104:119], v[168:171], v[96:99], 0
    v_exp_f32 v134, v134
    v_exp_f32 v135, v135
    v_exp_f32 v136, v136
    v_exp_f32 v137, v137
    v_smfmac_f32_32x32x32_bf16 v[152:167], v[220:223], v[128:135], v18
    v_exp_f32 v138, v138
    v_exp_f32 v139, v139
    v_exp_f32 v140, v140
    v_exp_f32 v141, v141
    v_mfma_f32_32x32x16_bf16 v[104:119], v[172:175], v[100:103], v[104:119]
    ds_read_b128 v[192:195], v6 offset:22528
    ds_read_b128 v[196:199], v6 offset:23552
    v_exp_f32 v142, v142
    v_exp_f32 v143, v143
    v_exp_f32 v144, v144
    v_exp_f32 v145, v145
    v_smfmac_f32_32x32x32_bf16 v[152:167], v[224:227], v[136:143], v18
    v_exp_f32 v146, v146
    v_exp_f32 v147, v147
    v_exp_f32 v148, v148
    v_exp_f32 v149, v149
    v_mfma_f32_32x32x16_bf16 v[120:135], v[176:179], v[96:99], 0
    v_exp_f32 v150, v150
    v_exp_f32 v151, v151
    s_waitcnt lgkmcnt(0)
    s_barrier
    ds_read_b128 v[200:203], v6 offset:32768
    ds_read_b128 v[204:207], v6 offset:33792
    v_exp_f32 v104, v104
    s_add_u32 m0, s56, 16384
    s_xor_b32 s51, s58, 163840
    v_exp_f32 v105, v105
    v_smfmac_f32_32x32x32_bf16 v[152:167], v[228:231], v[144:151], v18
    buffer_load_dwordx4 v5, s[20:23], s51 offen offset:0 sc1 lds
    v_exp_f32 v106, v106
    v_exp_f32 v107, v107
    v_exp_f32 v108, v108
    v_exp_f32 v109, v109
    v_mfma_f32_32x32x16_bf16 v[120:135], v[180:183], v[100:103], v[120:135]
    ds_read_b128 v[208:211], v6 offset:36864
    ds_read_b128 v[212:215], v6 offset:37888
    buffer_load_dwordx4 v5, s[20:23], s51 offen offset:1024 sc1 lds
    v_exp_f32 v110, v110
    v_exp_f32 v111, v111
    v_exp_f32 v112, v112
    s_add_u32 m0, s57, 28672
    s_mov_b32 s59, 114688
    v_exp_f32 v113, v113
    v_smfmac_f32_32x32x32_bf16 v[152:167], v[184:187], v[104:111], v18
    ds_read_b128 v[216:219], v6 offset:34816
    ds_read_b128 v[220:223], v6 offset:35840
    buffer_load_dwordx4 v78, s[16:19], s59 offen lds
    v_exp_f32 v114, v114
    v_exp_f32 v115, v115
    v_exp_f32 v116, v116
    v_exp_f32 v117, v117
    s_waitcnt lgkmcnt(2)
    v_mfma_f32_32x32x16_bf16 v[136:151], v[200:203], v[96:99], 0
    v_exp_f32 v118, v118
    v_exp_f32 v119, v119
    v_exp_f32 v120, v120
    v_exp_f32 v121, v121
    v_smfmac_f32_32x32x32_bf16 v[152:167], v[188:191], v[112:119], v18
    v_exp_f32 v122, v122
    v_exp_f32 v123, v123
    v_exp_f32 v124, v124
    v_exp_f32 v125, v125
    v_mfma_f32_32x32x16_bf16 v[136:151], v[204:207], v[100:103], v[136:151]
    ds_read_b128 v[224:227], v6 offset:38912
    ds_read_b128 v[228:231], v6 offset:39936
    v_exp_f32 v126, v126
    v_exp_f32 v127, v127
    v_exp_f32 v128, v128
    v_exp_f32 v129, v129
    v_smfmac_f32_32x32x32_bf16 v[152:167], v[192:195], v[120:127], v18
    v_exp_f32 v130, v130
    v_exp_f32 v131, v131
    v_exp_f32 v132, v132
    v_exp_f32 v133, v133
    v_mfma_f32_32x32x16_bf16 v[104:119], v[208:211], v[96:99], 0
    v_exp_f32 v134, v134
    v_exp_f32 v135, v135
    s_waitcnt lgkmcnt(0)
    s_barrier
    ds_read_b128 v[168:171], v6 offset:49152
    ds_read_b128 v[172:175], v6 offset:50176
    v_exp_f32 v136, v136
    s_add_u32 m0, s56, 32768
    s_xor_b32 s51, s58, 180224
    v_exp_f32 v137, v137
    v_smfmac_f32_32x32x32_bf16 v[152:167], v[196:199], v[128:135], v18
    buffer_load_dwordx4 v5, s[20:23], s51 offen offset:0 sc1 lds
    v_exp_f32 v138, v138
    v_exp_f32 v139, v139
    v_exp_f32 v140, v140
    v_exp_f32 v141, v141
    v_mfma_f32_32x32x16_bf16 v[104:119], v[212:215], v[100:103], v[104:119]
    ds_read_b128 v[176:179], v6 offset:53248
    ds_read_b128 v[180:183], v6 offset:54272
    buffer_load_dwordx4 v5, s[20:23], s51 offen offset:1024 sc1 lds
    v_exp_f32 v142, v142
    v_exp_f32 v143, v143
    v_exp_f32 v144, v144
    s_add_u32 m0, s57, 35840
    s_mov_b32 s59, 143360
    v_exp_f32 v145, v145
    v_smfmac_f32_32x32x32_bf16 v[152:167], v[216:219], v[136:143], v18
    ds_read_b128 v[184:187], v6 offset:51200
    ds_read_b128 v[188:191], v6 offset:52224
    buffer_load_dwordx4 v78, s[16:19], s59 offen lds
    v_exp_f32 v146, v146
    v_exp_f32 v147, v147
    v_exp_f32 v148, v148
    s_add_u32 m0, s57, 43008
    s_mov_b32 s59, 172032
    v_exp_f32 v149, v149
    s_waitcnt lgkmcnt(2)
    v_mfma_f32_32x32x16_bf16 v[120:135], v[168:171], v[96:99], 0
    buffer_load_dwordx4 v78, s[16:19], s59 offen lds
    v_exp_f32 v150, v150
    v_exp_f32 v151, v151
    v_exp_f32 v104, v104
    v_exp_f32 v105, v105
    v_smfmac_f32_32x32x32_bf16 v[152:167], v[220:223], v[144:151], v18
    v_exp_f32 v106, v106
    v_exp_f32 v107, v107
    v_exp_f32 v108, v108
    v_exp_f32 v109, v109
    v_mfma_f32_32x32x16_bf16 v[120:135], v[172:175], v[100:103], v[120:135]
    ds_read_b128 v[192:195], v6 offset:55296
    ds_read_b128 v[196:199], v6 offset:56320
    v_exp_f32 v110, v110
    v_exp_f32 v111, v111
    v_exp_f32 v112, v112
    v_exp_f32 v113, v113
    v_smfmac_f32_32x32x32_bf16 v[152:167], v[224:227], v[104:111], v18
    v_exp_f32 v114, v114
    v_exp_f32 v115, v115
    v_exp_f32 v116, v116
    v_exp_f32 v117, v117
    v_mfma_f32_32x32x16_bf16 v[136:151], v[176:179], v[96:99], 0
    v_exp_f32 v118, v118
    v_exp_f32 v119, v119
    s_waitcnt vmcnt(8) lgkmcnt(0)
    s_barrier
    ds_read_b128 v[200:203], v6 offset:0
    ds_read_b128 v[204:207], v6 offset:1024
    v_exp_f32 v120, v120
    s_add_u32 m0, s56, 49152
    s_xor_b32 s51, s58, 196608
    v_exp_f32 v121, v121
    v_smfmac_f32_32x32x32_bf16 v[152:167], v[228:231], v[112:119], v18
    buffer_load_dwordx4 v5, s[20:23], s51 offen offset:0 sc1 lds
    v_exp_f32 v122, v122
    v_exp_f32 v123, v123
    v_exp_f32 v124, v124
    v_exp_f32 v125, v125
    v_mfma_f32_32x32x16_bf16 v[136:151], v[180:183], v[100:103], v[136:151]
    ds_read_b128 v[208:211], v6 offset:4096
    ds_read_b128 v[212:215], v6 offset:5120
    buffer_load_dwordx4 v5, s[20:23], s51 offen offset:1024 sc1 lds
    v_exp_f32 v126, v126
    v_exp_f32 v127, v127
    v_exp_f32 v128, v128
    s_add_u32 m0, s57, 50176
    s_mov_b32 s59, 200704
    v_exp_f32 v129, v129
    v_smfmac_f32_32x32x32_bf16 v[152:167], v[184:187], v[120:127], v18
    ds_read_b128 v[216:219], v6 offset:2048
    ds_read_b128 v[220:223], v6 offset:3072
    buffer_load_dwordx4 v78, s[16:19], s59 offen lds
    v_exp_f32 v130, v130
    v_exp_f32 v131, v131
    v_exp_f32 v132, v132
    v_exp_f32 v133, v133
    s_waitcnt lgkmcnt(2)
    v_mfma_f32_32x32x16_bf16 v[104:119], v[200:203], v[96:99], 0
    v_exp_f32 v134, v134
    v_exp_f32 v135, v135
    v_exp_f32 v136, v136
    v_exp_f32 v137, v137
    v_smfmac_f32_32x32x32_bf16 v[152:167], v[188:191], v[128:135], v18
    v_exp_f32 v138, v138
    v_exp_f32 v139, v139
    v_exp_f32 v140, v140
    v_exp_f32 v141, v141
    v_mfma_f32_32x32x16_bf16 v[104:119], v[204:207], v[100:103], v[104:119]
    ds_read_b128 v[224:227], v6 offset:6144
    ds_read_b128 v[228:231], v6 offset:7168
    v_exp_f32 v142, v142
    v_exp_f32 v143, v143
    v_exp_f32 v144, v144
    v_exp_f32 v145, v145
    v_smfmac_f32_32x32x32_bf16 v[152:167], v[192:195], v[136:143], v18
    v_exp_f32 v146, v146
    v_exp_f32 v147, v147
    v_exp_f32 v148, v148
    v_exp_f32 v149, v149
    v_mfma_f32_32x32x16_bf16 v[120:135], v[208:211], v[96:99], 0
    v_exp_f32 v150, v150
    v_exp_f32 v151, v151
    s_waitcnt vmcnt(8) lgkmcnt(0)
    s_barrier
    ds_read_b128 v[168:171], v6 offset:16384
    ds_read_b128 v[172:175], v6 offset:17408
    v_exp_f32 v104, v104
    s_mov_b32 m0, s56
    s_xor_b32 s51, s58, 212992
    v_exp_f32 v105, v105
    v_smfmac_f32_32x32x32_bf16 v[152:167], v[196:199], v[144:151], v18
    buffer_load_dwordx4 v5, s[20:23], s51 offen offset:0 sc1 lds
    v_exp_f32 v106, v106
    v_exp_f32 v107, v107
    v_exp_f32 v108, v108
    v_exp_f32 v109, v109
    v_mfma_f32_32x32x16_bf16 v[120:135], v[212:215], v[100:103], v[120:135]
    ds_read_b128 v[176:179], v6 offset:20480
    ds_read_b128 v[180:183], v6 offset:21504
    buffer_load_dwordx4 v5, s[20:23], s51 offen offset:1024 sc1 lds
    v_exp_f32 v110, v110
    v_exp_f32 v111, v111
    v_exp_f32 v112, v112
    s_add_u32 m0, s57, 57344
    s_mov_b32 s59, 229376
    v_exp_f32 v113, v113
    v_smfmac_f32_32x32x32_bf16 v[152:167], v[216:219], v[104:111], v18
    ds_read_b128 v[184:187], v6 offset:18432
    ds_read_b128 v[188:191], v6 offset:19456
    buffer_load_dwordx4 v78, s[16:19], s59 offen lds
    v_exp_f32 v114, v114
    v_exp_f32 v115, v115
    v_exp_f32 v116, v116
    v_exp_f32 v117, v117
    s_waitcnt lgkmcnt(2)
    v_mfma_f32_32x32x16_bf16 v[136:151], v[168:171], v[96:99], 0
    v_exp_f32 v118, v118
    v_exp_f32 v119, v119
    v_exp_f32 v120, v120
    v_exp_f32 v121, v121
    v_smfmac_f32_32x32x32_bf16 v[152:167], v[220:223], v[112:119], v18
    v_exp_f32 v122, v122
    v_exp_f32 v123, v123
    v_exp_f32 v124, v124
    v_exp_f32 v125, v125
    v_mfma_f32_32x32x16_bf16 v[136:151], v[172:175], v[100:103], v[136:151]
    ds_read_b128 v[192:195], v6 offset:22528
    ds_read_b128 v[196:199], v6 offset:23552
    v_exp_f32 v126, v126
    v_exp_f32 v127, v127
    v_exp_f32 v128, v128
    v_exp_f32 v129, v129
    v_smfmac_f32_32x32x32_bf16 v[152:167], v[224:227], v[120:127], v18
    v_exp_f32 v130, v130
    v_exp_f32 v131, v131
    v_exp_f32 v132, v132
    v_exp_f32 v133, v133
    v_mfma_f32_32x32x16_bf16 v[104:119], v[176:179], v[96:99], 0
    v_exp_f32 v134, v134
    v_exp_f32 v135, v135
    s_waitcnt vmcnt(8) lgkmcnt(0)
    s_barrier
    ds_read_b128 v[200:203], v6 offset:32768
    ds_read_b128 v[204:207], v6 offset:33792
    v_exp_f32 v136, v136
    s_add_u32 m0, s56, 16384
    s_xor_b32 s51, s58, 229376
    v_exp_f32 v137, v137
    v_smfmac_f32_32x32x32_bf16 v[152:167], v[228:231], v[128:135], v18
    buffer_load_dwordx4 v5, s[20:23], s51 offen offset:0 sc1 lds
    v_exp_f32 v138, v138
    v_exp_f32 v139, v139
    v_exp_f32 v140, v140
    v_exp_f32 v141, v141
    v_mfma_f32_32x32x16_bf16 v[104:119], v[180:183], v[100:103], v[104:119]
    ds_read_b128 v[208:211], v6 offset:36864
    ds_read_b128 v[212:215], v6 offset:37888
    buffer_load_dwordx4 v5, s[20:23], s51 offen offset:1024 sc1 lds
    v_exp_f32 v142, v142
    v_exp_f32 v143, v143
    v_exp_f32 v144, v144
    s_add_u32 m0, s57, 64512
    s_mov_b32 s59, 258048
    v_exp_f32 v145, v145
    v_smfmac_f32_32x32x32_bf16 v[152:167], v[184:187], v[136:143], v18
    ds_read_b128 v[216:219], v6 offset:34816
    ds_read_b128 v[220:223], v6 offset:35840
    buffer_load_dwordx4 v78, s[16:19], s59 offen lds
    v_exp_f32 v146, v146
    v_exp_f32 v147, v147
    v_exp_f32 v148, v148
    v_exp_f32 v149, v149
    s_waitcnt lgkmcnt(2)
    v_mfma_f32_32x32x16_bf16 v[120:135], v[200:203], v[96:99], 0
    s_mul_i32 s52, s47, 28672
    buffer_load_dwordx4 v[52:55], v7, s[4:7], s52 offen
    v_exp_f32 v150, v150
    v_exp_f32 v151, v151
    v_exp_f32 v104, v104
    v_exp_f32 v105, v105
    v_smfmac_f32_32x32x32_bf16 v[152:167], v[188:191], v[144:151], v18
    v_exp_f32 v106, v106
    v_exp_f32 v107, v107
    v_exp_f32 v108, v108
    v_exp_f32 v109, v109
    v_mfma_f32_32x32x16_bf16 v[120:135], v[204:207], v[100:103], v[120:135]
    ds_read_b128 v[224:227], v6 offset:38912
    ds_read_b128 v[228:231], v6 offset:39936
    v_exp_f32 v110, v110
    v_exp_f32 v111, v111
    v_exp_f32 v112, v112
    v_exp_f32 v113, v113
    v_smfmac_f32_32x32x32_bf16 v[152:167], v[192:195], v[104:111], v18
    v_exp_f32 v114, v114
    v_exp_f32 v115, v115
    v_exp_f32 v116, v116
    v_exp_f32 v117, v117
    v_mfma_f32_32x32x16_bf16 v[136:151], v[208:211], v[96:99], 0
    v_exp_f32 v118, v118
    v_exp_f32 v119, v119
    s_waitcnt vmcnt(8) lgkmcnt(0)
    s_barrier
    ds_read_b128 v[168:171], v6 offset:49152
    ds_read_b128 v[172:175], v6 offset:50176
    v_exp_f32 v120, v120
    s_add_u32 m0, s56, 32768
    s_xor_b32 s51, s58, 245760
    v_exp_f32 v121, v121
    v_smfmac_f32_32x32x32_bf16 v[152:167], v[196:199], v[112:119], v18
    buffer_load_dwordx4 v5, s[20:23], s51 offen offset:0 sc1 lds
    v_exp_f32 v122, v122
    v_exp_f32 v123, v123
    v_exp_f32 v124, v124
    v_exp_f32 v125, v125
    v_mfma_f32_32x32x16_bf16 v[136:151], v[212:215], v[100:103], v[136:151]
    ds_read_b128 v[176:179], v6 offset:53248
    ds_read_b128 v[180:183], v6 offset:54272
    buffer_load_dwordx4 v5, s[20:23], s51 offen offset:1024 sc1 lds
    v_exp_f32 v126, v126
    v_exp_f32 v127, v127
    v_exp_f32 v128, v128
    s_add_u32 m0, s57, 71680
    s_mov_b32 s59, 286720
    v_exp_f32 v129, v129
    v_smfmac_f32_32x32x32_bf16 v[152:167], v[216:219], v[120:127], v18
    ds_read_b128 v[184:187], v6 offset:51200
    ds_read_b128 v[188:191], v6 offset:52224
    buffer_load_dwordx4 v78, s[16:19], s59 offen lds
    v_exp_f32 v130, v130
    v_exp_f32 v131, v131
    v_exp_f32 v132, v132
    s_add_u32 m0, s57, 78848
    s_mov_b32 s59, 315392
    v_exp_f32 v133, v133
    s_waitcnt lgkmcnt(2)
    v_mfma_f32_32x32x16_bf16 v[104:119], v[168:171], v[96:99], 0
    buffer_load_dwordx4 v78, s[16:19], s59 offen lds
    v_exp_f32 v134, v134
    v_exp_f32 v135, v135
    v_exp_f32 v136, v136
    v_exp_f32 v137, v137
    v_smfmac_f32_32x32x32_bf16 v[152:167], v[220:223], v[128:135], v18
    buffer_load_dwordx2 v[56:57], v17, s[32:35], 0 offen
    buffer_load_dwordx4 v[60:63], v2, s[32:35], 0 offen
    v_exp_f32 v138, v138
    v_exp_f32 v139, v139
    v_exp_f32 v140, v140
    v_exp_f32 v141, v141
    v_mfma_f32_32x32x16_bf16 v[104:119], v[172:175], v[100:103], v[104:119]
    ds_read_b128 v[192:195], v6 offset:55296
    ds_read_b128 v[196:199], v6 offset:56320
    v_exp_f32 v142, v142
    v_exp_f32 v143, v143
    v_exp_f32 v144, v144
    v_exp_f32 v145, v145
    v_smfmac_f32_32x32x32_bf16 v[152:167], v[224:227], v[136:143], v18
    v_exp_f32 v146, v146
    v_exp_f32 v147, v147
    v_exp_f32 v148, v148
    v_exp_f32 v149, v149
    v_mfma_f32_32x32x16_bf16 v[120:135], v[176:179], v[96:99], 0
    v_exp_f32 v150, v150
    v_exp_f32 v151, v151
    s_waitcnt vmcnt(11) lgkmcnt(0)
    s_barrier
    ds_read_b128 v[200:203], v6 offset:0
    ds_read_b128 v[204:207], v6 offset:1024
    v_exp_f32 v104, v104
    s_add_u32 m0, s57, 86016
    s_mov_b32 s59, 344064
    v_exp_f32 v105, v105
    v_smfmac_f32_32x32x32_bf16 v[152:167], v[228:231], v[144:151], v18
    buffer_load_dwordx4 v78, s[16:19], s59 offen lds
    v_exp_f32 v106, v106
    v_exp_f32 v107, v107
    v_exp_f32 v108, v108
    v_exp_f32 v109, v109
    v_mfma_f32_32x32x16_bf16 v[120:135], v[180:183], v[100:103], v[120:135]
    ds_read_b128 v[208:211], v6 offset:4096
    ds_read_b128 v[212:215], v6 offset:5120
    s_mov_b32 s52, 8388612
    buffer_load_dword v70, v16, s[20:23], s52 offen sc1
    v_exp_f32 v110, v110
    v_exp_f32 v111, v111
    v_exp_f32 v112, v112
    v_exp_f32 v113, v113
    v_smfmac_f32_32x32x32_bf16 v[152:167], v[184:187], v[104:111], v18
    ds_read_b128 v[216:219], v6 offset:2048
    ds_read_b128 v[220:223], v6 offset:3072
    v_exp_f32 v114, v114
    v_exp_f32 v115, v115
    v_exp_f32 v116, v116
    v_exp_f32 v117, v117
    s_waitcnt lgkmcnt(2)
    v_mfma_f32_32x32x16_bf16 v[136:151], v[200:203], v[96:99], 0
    v_exp_f32 v118, v118
    v_exp_f32 v119, v119
    v_exp_f32 v120, v120
    v_exp_f32 v121, v121
    v_smfmac_f32_32x32x32_bf16 v[152:167], v[188:191], v[112:119], v18
    v_exp_f32 v122, v122
    v_exp_f32 v123, v123
    v_exp_f32 v124, v124
    v_exp_f32 v125, v125
    v_mfma_f32_32x32x16_bf16 v[136:151], v[204:207], v[100:103], v[136:151]
    ds_read_b128 v[224:227], v6 offset:6144
    ds_read_b128 v[228:231], v6 offset:7168
    v_exp_f32 v126, v126
    v_exp_f32 v127, v127
    v_exp_f32 v128, v128
    v_exp_f32 v129, v129
    v_smfmac_f32_32x32x32_bf16 v[152:167], v[192:195], v[120:127], v18
    v_exp_f32 v130, v130
    v_exp_f32 v131, v131
    v_exp_f32 v132, v132
    v_exp_f32 v133, v133
    v_mfma_f32_32x32x16_bf16 v[104:119], v[208:211], v[96:99], 0
    v_exp_f32 v134, v134
    v_exp_f32 v135, v135
    s_waitcnt vmcnt(10) lgkmcnt(0)
    s_barrier
    ds_read_b128 v[168:171], v6 offset:16384
    ds_read_b128 v[172:175], v6 offset:17408
    v_exp_f32 v136, v136
    s_add_u32 m0, s57, 93184
    s_mov_b32 s59, 372736
    v_exp_f32 v137, v137
    v_smfmac_f32_32x32x32_bf16 v[152:167], v[196:199], v[128:135], v18
    buffer_load_dwordx4 v78, s[16:19], s59 offen lds
    v_exp_f32 v138, v138
    v_exp_f32 v139, v139
    v_exp_f32 v140, v140
    v_exp_f32 v141, v141
    v_mfma_f32_32x32x16_bf16 v[104:119], v[212:215], v[100:103], v[104:119]
    ds_read_b128 v[176:179], v6 offset:20480
    ds_read_b128 v[180:183], v6 offset:21504
    v_exp_f32 v142, v142
    v_exp_f32 v143, v143
    v_exp_f32 v144, v144
    v_exp_f32 v145, v145
    v_smfmac_f32_32x32x32_bf16 v[152:167], v[216:219], v[136:143], v18
    ds_read_b128 v[184:187], v6 offset:18432
    ds_read_b128 v[188:191], v6 offset:19456
    v_exp_f32 v146, v146
    v_exp_f32 v147, v147
    v_exp_f32 v148, v148
    v_exp_f32 v149, v149
    s_waitcnt lgkmcnt(2)
    v_mfma_f32_32x32x16_bf16 v[120:135], v[168:171], v[96:99], 0
    v_exp_f32 v150, v150
    v_exp_f32 v151, v151
    v_exp_f32 v104, v104
    v_exp_f32 v105, v105
    v_smfmac_f32_32x32x32_bf16 v[152:167], v[220:223], v[144:151], v18
    v_exp_f32 v106, v106
    v_exp_f32 v107, v107
    v_exp_f32 v108, v108
    v_exp_f32 v109, v109
    v_mfma_f32_32x32x16_bf16 v[120:135], v[172:175], v[100:103], v[120:135]
    ds_read_b128 v[192:195], v6 offset:22528
    ds_read_b128 v[196:199], v6 offset:23552
    v_exp_f32 v110, v110
    v_exp_f32 v111, v111
    v_exp_f32 v112, v112
    v_exp_f32 v113, v113
    v_smfmac_f32_32x32x32_bf16 v[152:167], v[224:227], v[104:111], v18
    v_exp_f32 v114, v114
    v_exp_f32 v115, v115
    v_exp_f32 v116, v116
    v_exp_f32 v117, v117
    v_mfma_f32_32x32x16_bf16 v[136:151], v[176:179], v[96:99], 0
    v_exp_f32 v118, v118
    v_exp_f32 v119, v119
    s_waitcnt vmcnt(7) lgkmcnt(0)
    s_barrier
    ds_read_b128 v[200:203], v6 offset:32768
    ds_read_b128 v[204:207], v6 offset:33792
    v_exp_f32 v120, v120
    s_mov_b32 m0, s57
    s_mov_b32 s59, 0
    v_exp_f32 v121, v121
    v_smfmac_f32_32x32x32_bf16 v[152:167], v[228:231], v[112:119], v18
    buffer_load_dwordx4 v78, s[16:19], s59 offen lds
    v_exp_f32 v122, v122
    v_exp_f32 v123, v123
    v_exp_f32 v124, v124
    v_exp_f32 v125, v125
    v_mfma_f32_32x32x16_bf16 v[136:151], v[180:183], v[100:103], v[136:151]
    ds_read_b128 v[208:211], v6 offset:36864
    ds_read_b128 v[212:215], v6 offset:37888
    v_exp_f32 v126, v126
    v_exp_f32 v127, v127
    v_exp_f32 v128, v128
    v_exp_f32 v129, v129
    v_smfmac_f32_32x32x32_bf16 v[152:167], v[184:187], v[120:127], v18
    ds_read_b128 v[216:219], v6 offset:34816
    ds_read_b128 v[220:223], v6 offset:35840
    v_exp_f32 v130, v130
    v_exp_f32 v131, v131
    v_exp_f32 v132, v132
    v_exp_f32 v133, v133
    s_waitcnt lgkmcnt(2)
    v_mfma_f32_32x32x16_bf16 v[104:119], v[200:203], v[96:99], 0
    v_exp_f32 v134, v134
    v_exp_f32 v135, v135
    v_exp_f32 v136, v136
    v_exp_f32 v137, v137
    v_smfmac_f32_32x32x32_bf16 v[152:167], v[188:191], v[128:135], v18
    v_exp_f32 v138, v138
    v_exp_f32 v139, v139
    v_exp_f32 v140, v140
    v_exp_f32 v141, v141
    v_mfma_f32_32x32x16_bf16 v[104:119], v[204:207], v[100:103], v[104:119]
    ds_read_b128 v[224:227], v6 offset:38912
    ds_read_b128 v[228:231], v6 offset:39936
    v_exp_f32 v142, v142
    v_exp_f32 v143, v143
    v_exp_f32 v144, v144
    v_exp_f32 v145, v145
    v_smfmac_f32_32x32x32_bf16 v[152:167], v[192:195], v[136:143], v18
    v_exp_f32 v146, v146
    v_exp_f32 v147, v147
    v_exp_f32 v148, v148
    v_exp_f32 v149, v149
    v_mfma_f32_32x32x16_bf16 v[120:135], v[208:211], v[96:99], 0
    v_exp_f32 v150, v150
    v_exp_f32 v151, v151
    s_waitcnt lgkmcnt(0)
    s_barrier
    v_exp_f32 v104, v104
    v_exp_f32 v105, v105
    v_smfmac_f32_32x32x32_bf16 v[152:167], v[196:199], v[144:151], v18
    s_waitcnt vmcnt(2)
    v_cmp_gt_u32 vcc, 16, v70
    s_and_b32 vcc_lo, vcc_lo, 0xffff
    s_cbranch_scc1 L_28
L_29:
    v_exp_f32 v106, v106
    v_exp_f32 v107, v107
    v_exp_f32 v108, v108
    v_exp_f32 v109, v109
    v_mfma_f32_32x32x16_bf16 v[120:135], v[212:215], v[100:103], v[120:135]
    v_exp_f32 v110, v110
    v_exp_f32 v111, v111
    v_exp_f32 v112, v112
    v_exp_f32 v113, v113
    v_smfmac_f32_32x32x32_bf16 v[152:167], v[216:219], v[104:111], v18
    v_exp_f32 v114, v114
    v_exp_f32 v115, v115
    v_exp_f32 v116, v116
    v_exp_f32 v117, v117
    v_exp_f32 v118, v118
    v_exp_f32 v119, v119
    s_nop 0
    v_exp_f32 v120, v120
    v_exp_f32 v121, v121
    v_smfmac_f32_32x32x32_bf16 v[152:167], v[220:223], v[112:119], v18
    v_exp_f32 v122, v122
    v_exp_f32 v123, v123
    v_exp_f32 v124, v124
    v_exp_f32 v125, v125
    v_exp_f32 v126, v126
    v_exp_f32 v127, v127
    v_exp_f32 v128, v128
    v_exp_f32 v129, v129
    v_smfmac_f32_32x32x32_bf16 v[152:167], v[224:227], v[120:127], v18
    v_exp_f32 v130, v130
    v_exp_f32 v131, v131
    v_exp_f32 v132, v132
    v_exp_f32 v133, v133
    v_exp_f32 v134, v134
    v_exp_f32 v135, v135
L_tail1:
    s_nop 1
    v_smfmac_f32_32x32x32_bf16 v[152:167], v[228:231], v[128:135], v18
    v_mov_b32 v14, 160804
    v_mov_b32 v15, 1
    s_mov_b32 s53, 0x71800000
    v_mov_b32 v21, v19
    s_nop 6
    s_nop 0
    v_mov_b32 v20, v164
    v_mov_b32 v13, v164
    ds_write_b128 v59, v[152:155]
    ds_write_b128 v59, v[156:159] offset:1024
    v_permlane32_swap_b32 v13, v20
    v_pk_add_f32 v[22:23], v[152:153], v[154:155]
    v_pk_add_f32 v[10:11], v[156:157], v[158:159]
    ds_write_b64 v59, v[20:21] offset:2048
    v_pk_add_f32 v[22:23], v[22:23], v[160:161]
    v_pk_add_f32 v[10:11], v[10:11], v[162:163]
    v_pk_add_f32 v[22:23], v[22:23], v[164:165]
    v_pk_add_f32 v[10:11], v[10:11], v[166:167]
    v_pk_add_f32 v[22:23], v[22:23], v[10:11]
    v_add_f32 v22, v22, v23
    v_add_f32 v22, abs(v22), v20
    v_cmp_ngt_f32 vcc, s53, v22
    s_mov_b64 exec, vcc
    ds_or_b32 v14, v15
    s_mov_b64 exec, -1
    s_waitcnt vmcnt(0) lgkmcnt(0)
    s_barrier
    ds_read_b64 v[22:23], v69 offset:2048
    ds_read_b32 v15, v14
    ds_read_b128 v[152:155], v69
    ds_read_b128 v[156:159], v69 offset:1024
    s_waitcnt lgkmcnt(3)
    v_max_f32 v10, v21, v23
    v_sub_f32 v21, v21, v10
    v_sub_f32 v23, v23, v10
    v_exp_f32 v21, v21
    v_exp_f32 v23, v23
    s_waitcnt lgkmcnt(2)
    v_readfirstlane_b32 s52, v15
    v_mul_f32 v20, v20, v21
    v_fmac_f32 v20, v22, v23
    s_cmp_gt_u32 s52, s63
    s_cbranch_scc1 L_fallback
    v_rcp_f32 v20, v20
    s_waitcnt lgkmcnt(0)
    v_mul_f32 v10, v21, v20
    v_mul_f32 v12, v23, v20
    v_pk_mul_f32 v[160:161], v[160:161], v[10:11] op_sel_hi:[1,0]
    v_pk_mul_f32 v[162:163], v[162:163], v[10:11] op_sel_hi:[1,0]
    v_pk_mul_f32 v[164:165], v[164:165], v[10:11] op_sel_hi:[1,0]
    v_pk_mul_f32 v[166:167], v[166:167], v[10:11] op_sel_hi:[1,0]
    v_pk_fma_f32 v[160:161], v[152:153], v[12:13], v[160:161] op_sel_hi:[1,0,1]
    v_pk_fma_f32 v[162:163], v[154:155], v[12:13], v[162:163] op_sel_hi:[1,0,1]
    v_pk_fma_f32 v[164:165], v[156:157], v[12:13], v[164:165] op_sel_hi:[1,0,1]
    v_pk_fma_f32 v[166:167], v[158:159], v[12:13], v[166:167] op_sel_hi:[1,0,1]
    v_cvt_pk_bf16_f32 v232, v160, v161
    v_cvt_pk_bf16_f32 v233, v162, v163
    v_cvt_pk_bf16_f32 v234, v164, v165
    v_cvt_pk_bf16_f32 v235, v166, v167
    s_mov_b32 exec_lo, 0
    v_mov_b32 v234, 0
    s_mov_b32 exec_lo, -1
    buffer_store_dwordx4 v[232:235], v2, s[20:23], s60 offen sc1
L_loopd:
    s_lshr_b32 s54, s47, 2
    s_lshl_b32 s54, s54, 10
    s_add_u32 s54, s54, 8388736
    s_cmp_eq_u32 s40, 7
    s_cselect_b32 s54, s54, 0x40000000
    s_mov_b64 exec, 1
    v_mov_b32 v12, 0
    buffer_atomic_add v12, v12, s[20:23], s54 offen sc0 sc1
    s_mov_b64 exec, -1
    v_bfe_u32 v11, v0, 4, 1
    v_lshlrev_b32 v10, 4, v4
    v_lshl_add_u32 v10, v11, 2, v10
    v_bfe_u32 v11, v0, 2, 2
    v_add_u32 v10, v10, v11
    v_mul_u32_u24 v10, 224, v10
    v_and_b32 v11, 3, v0
    v_lshl_add_u32 v10, v11, 3, v10
    s_lshl_b32 s53, s40, 5
    s_add_u32 s53, s53, 58368
    v_add_u32 v58, s53, v10
    v_add_u32 v11, 50176, v58
    ds_read_b64_tr_b16 v[168:169], v58 offset:0
    ds_read_b64_tr_b16 v[170:171], v58 offset:1792
    ds_read_b64_tr_b16 v[172:173], v58 offset:6272
    ds_read_b64_tr_b16 v[174:175], v58 offset:8064
    ds_read_b64_tr_b16 v[176:177], v58 offset:12544
    ds_read_b64_tr_b16 v[178:179], v58 offset:14336
    ds_read_b64_tr_b16 v[180:181], v58 offset:18816
    ds_read_b64_tr_b16 v[182:183], v58 offset:20608
    s_waitcnt lgkmcnt(4)
    ds_read_b64_tr_b16 v[184:185], v58 offset:25088
    ds_read_b64_tr_b16 v[186:187], v58 offset:26880
    ds_read_b64_tr_b16 v[188:189], v58 offset:31360
    ds_read_b64_tr_b16 v[190:191], v58 offset:33152
    ds_read_b64_tr_b16 v[192:193], v58 offset:37632
    ds_read_b64_tr_b16 v[194:195], v58 offset:39424
    ds_read_b64_tr_b16 v[196:197], v58 offset:43904
    ds_read_b64_tr_b16 v[198:199], v58 offset:45696
    s_waitcnt lgkmcnt(4)
    ds_read_b64_tr_b16 v[200:201], v11 offset:0
    ds_read_b64_tr_b16 v[202:203], v11 offset:1792
    ds_read_b64_tr_b16 v[204:205], v11 offset:6272
    ds_read_b64_tr_b16 v[206:207], v11 offset:8064
    ds_read_b64_tr_b16 v[208:209], v11 offset:12544
    ds_read_b64_tr_b16 v[210:211], v11 offset:14336
    ds_read_b64_tr_b16 v[212:213], v11 offset:18816
    ds_read_b64_tr_b16 v[214:215], v11 offset:20608
    s_waitcnt lgkmcnt(4)
    ds_read_b64_tr_b16 v[216:217], v11 offset:25088
    ds_read_b64_tr_b16 v[218:219], v11 offset:26880
    ds_read_b64_tr_b16 v[220:221], v11 offset:31360
    ds_read_b64_tr_b16 v[222:223], v11 offset:33152
    ds_read_b64_tr_b16 v[224:225], v11 offset:37632
    ds_read_b64_tr_b16 v[226:227], v11 offset:39424
    ds_read_b64_tr_b16 v[228:229], v11 offset:43904
    ds_read_b64_tr_b16 v[230:231], v11 offset:45696
    s_lshl_b32 s52, s47, 15
    s_add_u32 s52, s52, 4194304
    s_cmp_lg_u32 s40, 7
    s_cbranch_scc1 L_30_
    s_mov_b64 exec, 1
    s_mov_b32 s55, 0x20000
L_30:
    s_waitcnt vmcnt(0)
L_30x:
    v_readfirstlane_b32 s53, v12
    s_sub_u32 s55, s55, 1
    s_cselect_b32 s53, 16, s53
    s_cmp_ge_u32 s53, 16
    s_cbranch_scc1 L_30_
    v_mov_b32 v12, 0
    buffer_atomic_add v12, v12, s[20:23], s54 offen sc0 sc1
    s_branch L_30
L_30_:
    s_mov_b64 exec, -1
    s_waitcnt lgkmcnt(0)
    s_barrier
    s_waitcnt vmcnt(0)
    buffer_load_dwordx4 v[104:107], v59, s[20:23], s52 offen offset:0 sc1
    buffer_load_dwordx4 v[108:111], v59, s[20:23], s52 offen offset:1024 sc1
    buffer_load_dwordx4 v[112:115], v59, s[20:23], s52 offen offset:2048 sc1
    buffer_load_dwordx4 v[116:119], v59, s[20:23], s52 offen offset:3072 sc1
    ds_write_b128 v71, v[52:55] offset:32768
    v_mov_b32 v76, 0x3f803f80
    v_mov_b32 v144, 0
    v_mov_b32 v145, 0
    v_mov_b32 v146, 0
    v_mov_b32 v147, 0
    v_mov_b32 v148, 0
    v_mov_b32 v149, 0
    v_mul_u32_u24 v10, 4682, v0
    v_lshrrev_b32 v10, 16, v10
    v_lshlrev_b32 v67, 3, v10
    s_lshl_b32 s53, s40, 5
    v_lshrrev_b32 v12, 4, v1
    v_lshl_add_u32 v13, v12, 3, s53
    v_and_b32 v11, 15, v0
    v_mul_u32_u24 v10, 224, v11
    v_add_u32 v65, v10, v13
    v_lshlrev_b32 v10, 4, v11
    v_lshl_add_u32 v64, v12, 9, v10
    v_lshl_add_u32 v10, v4, 8, v10
    v_bfe_u32 v11, v0, 4, 1
    v_lshl_add_u32 v10, v11, 2, v10
    v_lshl_add_u32 v66, s40, 9, v10
    v_add_u32 v66, 40960, v66
    s_mov_b32 s55, 0x20000
L_31:
    s_waitcnt vmcnt(0)
    ds_write_b128 v59, v[104:107] offset:0
    ds_write_b128 v59, v[108:111] offset:1024
    ds_write_b128 v59, v[112:115] offset:2048
    ds_write_b128 v59, v[116:119] offset:3072
    v_max3_u32 v10, v104, v105, v106
    v_max3_u32 v11, v107, v108, v109
    v_max3_u32 v10, v10, v110, v111
    v_max3_u32 v11, v11, v112, v113
    v_max3_u32 v10, v10, v114, v115
    v_max3_u32 v11, v11, v116, v117
    v_max3_u32 v10, v10, v118, v119
    v_max_u32 v10, v10, v11
    v_cmp_eq_u32 vcc, -1, v10
    s_cbranch_vccz L_32
    s_sub_u32 s55, s55, 1
    s_cbranch_scc1 L_32
    s_waitcnt lgkmcnt(0)
    buffer_load_dwordx4 v[104:107], v59, s[20:23], s52 offen offset:0 sc1
    buffer_load_dwordx4 v[108:111], v59, s[20:23], s52 offen offset:1024 sc1
    buffer_load_dwordx4 v[112:115], v59, s[20:23], s52 offen offset:2048 sc1
    buffer_load_dwordx4 v[116:119], v59, s[20:23], s52 offen offset:3072 sc1
    s_branch L_31
L_32:
    s_waitcnt lgkmcnt(0)
    s_barrier
    s_cmp_eq_u32 s40, 7
    s_cbranch_scc1 L_w7a
    ds_read_b128 v[104:107], v64 offset:0
    ds_read_b128 v[108:111], v64 offset:256
    ds_read_b128 v[112:115], v64 offset:2048
    ds_read_b128 v[116:119], v64 offset:2304
    ds_read_b128 v[120:123], v64 offset:4096
    ds_read_b128 v[124:127], v64 offset:4352
    ds_read_b128 v[128:131], v64 offset:6144
    ds_read_b128 v[132:135], v64 offset:6400
    s_waitcnt lgkmcnt(6)
    v_mfma_f32_16x16x32_bf16 v[160:163], v[168:171], v[104:107], 0
    ds_read_b128 v[104:107], v64 offset:8192
    v_mfma_f32_16x16x32_bf16 v[164:167], v[168:171], v[108:111], 0
    ds_read_b128 v[108:111], v64 offset:8448
    s_waitcnt lgkmcnt(6)
    v_mfma_f32_16x16x32_bf16 v[160:163], v[172:175], v[112:115], v[160:163]
    ds_read_b128 v[112:115], v64 offset:10240
    v_mfma_f32_16x16x32_bf16 v[164:167], v[172:175], v[116:119], v[164:167]
    ds_read_b128 v[116:119], v64 offset:10496
    s_waitcnt lgkmcnt(6)
    v_mfma_f32_16x16x32_bf16 v[160:163], v[176:179], v[120:123], v[160:163]
    ds_read_b128 v[120:123], v64 offset:12288
    v_mfma_f32_16x16x32_bf16 v[164:167], v[176:179], v[124:127], v[164:167]
    ds_read_b128 v[124:127], v64 offset:12544
    s_waitcnt lgkmcnt(6)
    v_mfma_f32_16x16x32_bf16 v[160:163], v[180:183], v[128:131], v[160:163]
    ds_read_b128 v[128:131], v64 offset:14336
    v_mfma_f32_16x16x32_bf16 v[164:167], v[180:183], v[132:135], v[164:167]
    ds_read_b128 v[132:135], v64 offset:14592
    s_waitcnt lgkmcnt(6)
    v_mfma_f32_16x16x32_bf16 v[160:163], v[184:187], v[104:107], v[160:163]
    ds_read_b128 v[104:107], v64 offset:16384
    v_mfma_f32_16x16x32_bf16 v[164:167], v[184:187], v[108:111], v[164:167]
    ds_read_b128 v[108:111], v64 offset:16640
    s_waitcnt lgkmcnt(6)
    v_mfma_f32_16x16x32_bf16 v[160:163], v[188:191], v[112:115], v[160:163]
    ds_read_b128 v[112:115], v64 offset:18432
    v_mfma_f32_16x16x32_bf16 v[164:167], v[188:191], v[116:119], v[164:167]
    ds_read_b128 v[116:119], v64 offset:18688
    s_waitcnt lgkmcnt(6)
    v_mfma_f32_16x16x32_bf16 v[160:163], v[192:195], v[120:123], v[160:163]
    ds_read_b128 v[120:123], v64 offset:20480
    v_mfma_f32_16x16x32_bf16 v[164:167], v[192:195], v[124:127], v[164:167]
    ds_read_b128 v[124:127], v64 offset:20736
    s_waitcnt lgkmcnt(6)
    v_mfma_f32_16x16x32_bf16 v[160:163], v[196:199], v[128:131], v[160:163]
    ds_read_b128 v[128:131], v64 offset:22528
    ds_read_b64 v[52:53], v65 offset:32768
    ds_read_b64 v[54:55], v65 offset:36352
    v_mfma_f32_16x16x32_bf16 v[164:167], v[196:199], v[132:135], v[164:167]
    ds_read_b128 v[132:135], v64 offset:22784
    s_waitcnt lgkmcnt(8)
    v_mfma_f32_16x16x32_bf16 v[160:163], v[200:203], v[104:107], v[160:163]
    ds_read_b128 v[104:107], v64 offset:24576
    v_mfma_f32_16x16x32_bf16 v[164:167], v[200:203], v[108:111], v[164:167]
    ds_read_b128 v[108:111], v64 offset:24832
    s_waitcnt lgkmcnt(8)
    v_mfma_f32_16x16x32_bf16 v[160:163], v[204:207], v[112:115], v[160:163]
    ds_read_b128 v[112:115], v64 offset:26624
    v_mfma_f32_16x16x32_bf16 v[164:167], v[204:207], v[116:119], v[164:167]
    ds_read_b128 v[116:119], v64 offset:26880
    s_waitcnt lgkmcnt(8)
    v_mfma_f32_16x16x32_bf16 v[160:163], v[208:211], v[120:123], v[160:163]
    ds_read_b128 v[120:123], v64 offset:28672
    v_mfma_f32_16x16x32_bf16 v[164:167], v[208:211], v[124:127], v[164:167]
    ds_read_b128 v[124:127], v64 offset:28928
    s_waitcnt lgkmcnt(6)
    v_mfma_f32_16x16x32_bf16 v[160:163], v[212:215], v[128:131], v[160:163]
    ds_read_b128 v[128:131], v64 offset:30720
    v_mfma_f32_16x16x32_bf16 v[164:167], v[212:215], v[132:135], v[164:167]
    ds_read_b128 v[132:135], v64 offset:30976
    s_waitcnt lgkmcnt(6)
    v_mfma_f32_16x16x32_bf16 v[160:163], v[216:219], v[104:107], v[160:163]
    v_lshlrev_b32 v152, 16, v52
    v_mfma_f32_16x16x32_bf16 v[164:167], v[216:219], v[108:111], v[164:167]
    v_and_b32 v153, 0xffff0000, v52
    s_waitcnt lgkmcnt(4)
    v_mfma_f32_16x16x32_bf16 v[160:163], v[220:223], v[112:115], v[160:163]
    v_lshlrev_b32 v154, 16, v53
    v_mfma_f32_16x16x32_bf16 v[164:167], v[220:223], v[116:119], v[164:167]
    v_and_b32 v155, 0xffff0000, v53
    s_waitcnt lgkmcnt(2)
    v_mfma_f32_16x16x32_bf16 v[160:163], v[224:227], v[120:123], v[160:163]
    v_lshlrev_b32 v156, 16, v54
    v_mfma_f32_16x16x32_bf16 v[164:167], v[224:227], v[124:127], v[164:167]
    v_and_b32 v157, 0xffff0000, v54
    s_waitcnt lgkmcnt(0)
    v_mfma_f32_16x16x32_bf16 v[160:163], v[228:231], v[128:131], v[160:163]
    v_lshlrev_b32 v158, 16, v55
    v_mfma_f32_16x16x32_bf16 v[164:167], v[228:231], v[132:135], v[164:167]
    v_and_b32 v159, 0xffff0000, v55
    s_nop 4
    v_cvt_pk_bf16_f32 v160, v160, v161
    v_cvt_pk_bf16_f32 v162, v162, v163
    v_and_b32 v161, 0xffff0000, v160
    v_lshlrev_b32 v160, 16, v160
    v_and_b32 v163, 0xffff0000, v162
    v_lshlrev_b32 v162, 16, v162
    v_pk_add_f32 v[160:161], v[160:161], v[152:153]
    v_pk_add_f32 v[162:163], v[162:163], v[154:155]
    v_cvt_pk_bf16_f32 v136, v160, v161
    v_cvt_pk_bf16_f32 v137, v162, v163
    v_cvt_pk_bf16_f32 v164, v164, v165
    v_cvt_pk_bf16_f32 v166, v166, v167
    v_and_b32 v165, 0xffff0000, v164
    v_lshlrev_b32 v164, 16, v164
    v_and_b32 v167, 0xffff0000, v166
    v_lshlrev_b32 v166, 16, v166
    v_pk_add_f32 v[164:165], v[164:165], v[156:157]
    v_pk_add_f32 v[166:167], v[166:167], v[158:159]
    v_cvt_pk_bf16_f32 v138, v164, v165
    v_cvt_pk_bf16_f32 v139, v166, v167
    ds_write_b64 v65, v[136:137] offset:32768
    ds_write_b64 v65, v[138:139] offset:36352
    v_dot2c_f32_bf16 v144, v136, v76
    v_dot2c_f32_bf16 v146, v136, v136
    v_dot2c_f32_bf16 v148, v136, v56
    v_dot2c_f32_bf16 v145, v138, v76
    v_dot2c_f32_bf16 v147, v138, v138
    v_dot2c_f32_bf16 v149, v138, v56
    v_dot2c_f32_bf16 v144, v137, v76
    v_dot2c_f32_bf16 v146, v137, v137
    v_dot2c_f32_bf16 v148, v137, v57
    v_dot2c_f32_bf16 v145, v139, v76
    v_dot2c_f32_bf16 v147, v139, v139
    v_dot2c_f32_bf16 v149, v139, v57
    s_nop 0
    v_permlane32_swap_b32 v144, v145
    v_permlane32_swap_b32 v146, v147
    v_permlane32_swap_b32 v148, v149
    v_add_f32 v144, v144, v145
    v_add_f32 v146, v146, v147
    v_add_f32 v148, v148, v149
    v_mov_b32 v149, v148
    v_permlane16_swap_b32 v144, v146
    v_add_f32 v144, v144, v146
    v_permlane16_swap_b32 v148, v149
    v_add_f32 v148, v148, v149
    ds_write2_b32 v66, v144, v148 offset0:0 offset1:2
    s_waitcnt lgkmcnt(0)
    s_barrier
    s_mov_b32 s26, 1835008
    s_mov_b32 s27, 0x20000
    ds_read_b128 v[104:107], v71 offset:32768
    s_mul_i32 s52, s47, 28672
    s_add_u32 s53, s52, 6291456
    s_waitcnt lgkmcnt(0)
    v_min_u32 v104, -2, v104
    v_min_u32 v105, -2, v105
    v_min_u32 v106, -2, v106
    v_min_u32 v107, -2, v107
    buffer_store_dwordx4 v[104:107], v7, s[20:23], s53 offen sc1
    v_lshlrev_b32 v108, 16, v104
    v_and_b32 v109, 0xffff0000, v104
    v_lshlrev_b32 v110, 16, v105
    v_and_b32 v111, 0xffff0000, v105
    v_lshlrev_b32 v112, 16, v106
    v_and_b32 v113, 0xffff0000, v106
    v_lshlrev_b32 v114, 16, v107
    v_and_b32 v115, 0xffff0000, v107
    s_cmp_eq_u32 s49, 0
    s_cbranch_scc1 L_33
    s_mul_i32 s53, s40, 7168
    s_add_u32 s53, s53, 65536
    v_add_u32 v13, s53, v2
    s_mul_i32 s53, s40, 3712
    s_add_u32 s53, s53, 131072
    v_add_u32 v12, s53, v2
    ds_write_b128 v13, v[24:27] offset:0
    ds_write_b128 v13, v[28:31] offset:1024
    ds_write_b128 v13, v[32:35] offset:2048
    ds_write_b128 v13, v[36:39] offset:3072
    ds_write_b128 v13, v[40:43] offset:4096
    ds_write_b128 v13, v[44:47] offset:5120
    ds_write_b128 v13, v[48:51] offset:6144
    s_mov_b32 exec_hi, 0xffffff
    ds_write_b128 v12, v[80:83] offset:0
    ds_write_b128 v12, v[84:87] offset:928
    ds_write_b128 v12, v[88:91] offset:1856
    ds_write_b128 v12, v[92:95] offset:2784
    s_mov_b32 exec_hi, -1
L_33:
    v_mov_b32 v12, 0
    v_mov_b32 v13, 0
    v_mov_b32 v14, 0
    v_mov_b32 v15, 0
    v_add_u32 v10, 122880, v71
    ds_write_b128 v10, v[12:15]
    s_branch L_p3j
L_w7a:
    s_cmp_eq_u32 s49, 0
    s_cbranch_scc1 L_34
    s_mul_i32 s53, s40, 7168
    s_add_u32 s53, s53, 65536
    v_add_u32 v13, s53, v2
    s_mul_i32 s53, s40, 3712
    s_add_u32 s53, s53, 131072
    v_add_u32 v12, s53, v2
    ds_write_b128 v13, v[24:27] offset:0
    ds_write_b128 v13, v[28:31] offset:1024
    ds_write_b128 v13, v[32:35] offset:2048
    ds_write_b128 v13, v[36:39] offset:3072
    ds_write_b128 v13, v[40:43] offset:4096
    ds_write_b128 v13, v[44:47] offset:5120
    ds_write_b128 v13, v[48:51] offset:6144
    s_mov_b32 exec_hi, 0xffffff
    ds_write_b128 v12, v[80:83] offset:0
    ds_write_b128 v12, v[84:87] offset:928
    ds_write_b128 v12, v[88:91] offset:1856
    ds_write_b128 v12, v[92:95] offset:2784
    s_mov_b32 exec_hi, -1
L_34:
    v_mov_b32 v12, 0
    v_mov_b32 v13, 0
    v_mov_b32 v14, 0
    v_mov_b32 v15, 0
    v_add_u32 v10, 122880, v71
    ds_write_b128 v10, v[12:15]
    s_mov_b32 s26, 1835008
    s_mov_b32 s27, 0x20000
    v_mov_b32 v20, 0
    v_dot2c_f32_bf16 v20, v60, v76
    v_dot2c_f32_bf16 v20, v61, v76
    v_dot2c_f32_bf16 v20, v62, v76
    v_dot2c_f32_bf16 v20, v63, v76
    s_nop 2
    v_add_f32_dpp v20, v20, v20 quad_perm:[1,0,3,2] row_mask:0xf bank_mask:0xf
    s_nop 1
    v_add_f32_dpp v20, v20, v20 quad_perm:[2,3,0,1] row_mask:0xf bank_mask:0xf
    s_nop 1
    v_add_f32_dpp v20, v20, v20 row_half_mirror row_mask:0xf bank_mask:0xf
    s_nop 1
    v_add_f32_dpp v20, v20, v20 row_mirror row_mask:0xf bank_mask:0xf
    v_mov_b32 v21, v20
    v_lshlrev_b32 v10, 3, v4
    v_lshl_add_u32 v10, v3, 4, v10
    v_permlane16_swap_b32 v20, v21
    s_lshl_b32 s52, s47, 11
    s_add_u32 s52, s52, 8126464
    s_lshl_b32 s53, s48, 9
    s_add_u32 s53, s53, s52
    v_add_f32 v20, v20, v21
    v_mov_b32 v21, v20
    v_lshlrev_b32 v14, 3, v1
    s_nop 0
    v_permlane32_swap_b32 v20, v21
    v_add_f32 v20, v20, v21
    s_waitcnt lgkmcnt(0)
    s_barrier
    ds_read_b64 v[104:105], v10 offset:40960
    ds_read_b64 v[106:107], v10 offset:41472
    ds_read_b64 v[108:109], v10 offset:41984
    ds_read_b64 v[110:111], v10 offset:42496
    ds_read_b64 v[112:113], v10 offset:43008
    ds_read_b64 v[114:115], v10 offset:43520
    ds_read_b64 v[116:117], v10 offset:44032
    s_waitcnt lgkmcnt(3)
    v_pk_add_f32 v[104:105], v[104:105], v[106:107]
    v_pk_add_f32 v[108:109], v[108:109], v[110:111]
    s_waitcnt lgkmcnt(0)
    v_pk_add_f32 v[112:113], v[112:113], v[114:115]
    v_pk_add_f32 v[104:105], v[104:105], v[108:109]
    v_pk_add_f32 v[112:113], v[112:113], v[116:117]
    v_pk_add_f32 v[120:121], v[104:105], v[112:113]
    buffer_store_dwordx2 v[120:121], v14, s[20:23], s53 offen sc1
    s_mov_b32 s55, 0x20000
    s_waitcnt vmcnt(0)
L_35:
    buffer_load_dwordx2 v[108:109], v14, s[20:23], s52 offen sc1
    buffer_load_dwordx2 v[110:111], v14, s[20:23], s52 offen offset:512 sc1
    buffer_load_dwordx2 v[112:113], v14, s[20:23], s52 offen offset:1024 sc1
    buffer_load_dwordx2 v[114:115], v14, s[20:23], s52 offen offset:1536 sc1
    s_sub_u32 s55, s55, 1
    s_waitcnt vmcnt(0)
    v_pk_add_f32 v[104:105], v[108:109], v[110:111]
    v_pk_add_f32 v[106:107], v[112:113], v[114:115]
    s_cbranch_scc1 L_36
    v_max3_u32 v12, v108, v109, v110
    v_max3_u32 v11, v111, v112, v113
    v_max3_u32 v12, v12, v114, v115
    v_max_u32 v12, v12, v11
    v_cmp_eq_u32 vcc, -1, v12
    s_cbranch_vccnz L_35
L_36:
    v_pk_add_f32 v[104:105], v[104:105], v[106:107]
    v_mov_b32 v106, v104
    v_mov_b32 v107, v105
    s_nop 0
    v_permlane32_swap_b32 v104, v106
    v_permlane32_swap_b32 v105, v107
    v_mul_f32 v104, 0x3b124925, v104
    v_mul_f32 v105, 0x3b124925, v105
    v_fma_f32 v105, -v104, v104, v105
    v_cvt_pk_bf16_f32 v104, v104, v104
    v_max_f32 v105, 0, v105
    v_cvt_pk_bf16_f32 v105, v105, v105
    v_and_b32 v104, 0xffff0000, v104
    v_and_b32 v105, 0xffff0000, v105
    v_add_f32 v105, 0x3727c5ac, v105
    v_fma_f32 v106, -v104, v20, v106
    v_cvt_pk_bf16_f32 v105, v105, v105
    v_and_b32 v105, 0xffff0000, v105
    v_sqrt_f32 v105, v105
    s_lshl_b32 s52, s47, 5
    s_sub_u32 s52, 2047, s52
    v_cvt_pk_bf16_f32 v105, v105, v105
    v_and_b32 v105, 0xffff0000, v105
    v_rcp_f32 v105, v105
    v_sub_u32 v11, s52, v3
    v_lshlrev_b32 v13, 3, v3
    v_mul_f32 v106, v106, v105
    ds_write_b64 v13, v[104:105] offset:45056
    s_cmp_lg_u32 s48, 0
    s_cbranch_scc1 L_w7z
    v_ashrrev_i32 v10, 31, v106
    v_or_b32 v10, 0x80000000, v10
    v_xor_b32 v10, v10, v106
    v_and_b32 v10, 0xfffff800, v10
    v_or_b32 v10, v10, v11
    v_med3_u32 v10, v10, 1, -2
    v_cvt_pk_bf16_f32 v106, v106, v106
    s_lshl_b32 s52, s47, 7
    s_add_u32 s52, s52, 8257536
    v_lshlrev_b32 v11, 2, v3
    s_mov_b32 exec_hi, 0
    buffer_store_dword v10, v11, s[20:23], s52 offen sc1
    v_and_b32 v106, 0xffff0000, v106
    v_mul_f32 v106, 0xbfb8aa3b, v106
    v_exp_f32 v106, v106
    s_lshl_b32 s52, s47, 9
    s_add_u32 s52, s52, 8265728
    v_add_f32 v106, 1.0, v106
    v_rcp_f32 v106, v106
    s_nop 0
    v_cvt_pk_bf16_f32 v106, v106, v106
    s_lshl_b32 s53, s47, 5
    v_add_u32 v107, s53, v3
    v_and_b32 v106, 0xffff0000, v106
    buffer_store_dwordx4 v[104:107], v2, s[20:23], s52 offen sc1
    s_mov_b32 exec_hi, -1
L_w7z:
L_p3j:
    s_waitcnt lgkmcnt(0)
    s_barrier
    s_cmp_eq_u32 s40, 7
    s_cbranch_scc1 L_outd
    ds_read_b64 v[12:13], v67 offset:45056
    s_mul_i32 s52, s47, 28672
    s_waitcnt lgkmcnt(0)
    v_pk_add_f32 v[116:117], v[108:109], v[12:13] op_sel_hi:[1,0] neg_lo:[0,1] neg_hi:[0,1]
    v_pk_add_f32 v[118:119], v[110:111], v[12:13] op_sel_hi:[1,0] neg_lo:[0,1] neg_hi:[0,1]
    v_pk_add_f32 v[120:121], v[112:113], v[12:13] op_sel_hi:[1,0] neg_lo:[0,1] neg_hi:[0,1]
    v_pk_add_f32 v[122:123], v[114:115], v[12:13] op_sel_hi:[1,0] neg_lo:[0,1] neg_hi:[0,1]
    v_cvt_pk_bf16_f32 v116, v116, v117
    v_cvt_pk_bf16_f32 v118, v118, v119
    v_cvt_pk_bf16_f32 v120, v120, v121
    v_cvt_pk_bf16_f32 v122, v122, v123
    v_and_b32 v117, 0xffff0000, v116
    v_lshlrev_b32 v116, 16, v116
    v_and_b32 v119, 0xffff0000, v118
    v_lshlrev_b32 v118, 16, v118
    v_and_b32 v121, 0xffff0000, v120
    v_lshlrev_b32 v120, 16, v120
    v_and_b32 v123, 0xffff0000, v122
    v_lshlrev_b32 v122, 16, v122
    v_pk_mul_f32 v[116:117], v[116:117], v[12:13] op_sel:[0,1] op_sel_hi:[1,1]
    v_pk_mul_f32 v[118:119], v[118:119], v[12:13] op_sel:[0,1] op_sel_hi:[1,1]
    v_pk_mul_f32 v[120:121], v[120:121], v[12:13] op_sel:[0,1] op_sel_hi:[1,1]
    v_pk_mul_f32 v[122:123], v[122:123], v[12:13] op_sel:[0,1] op_sel_hi:[1,1]
    v_cvt_pk_bf16_f32 v116, v116, v117
    v_cvt_pk_bf16_f32 v118, v118, v119
    v_cvt_pk_bf16_f32 v120, v120, v121
    v_cvt_pk_bf16_f32 v122, v122, v123
    v_and_b32 v117, 0xffff0000, v116
    v_lshlrev_b32 v116, 16, v116
    v_and_b32 v119, 0xffff0000, v118
    v_lshlrev_b32 v118, 16, v118
    v_and_b32 v121, 0xffff0000, v120
    v_lshlrev_b32 v120, 16, v120
    v_and_b32 v123, 0xffff0000, v122
    v_lshlrev_b32 v122, 16, v122
    v_pk_add_f32 v[116:117], v[116:117], v[108:109]
    v_pk_add_f32 v[118:119], v[118:119], v[110:111]
    v_pk_add_f32 v[120:121], v[120:121], v[112:113]
    v_pk_add_f32 v[122:123], v[122:123], v[114:115]
    v_cvt_pk_bf16_f32 v124, v116, v117
    v_cvt_pk_bf16_f32 v125, v118, v119
    v_cvt_pk_bf16_f32 v126, v120, v121
    v_cvt_pk_bf16_f32 v127, v122, v123
    buffer_store_dwordx4 v[124:127], v7, s[24:27], s52 offen sc1
L_outd:
    s_cmp_eq_u32 s49, 0
    s_cbranch_scc0 L_37
    s_waitcnt vmcnt(0)
    s_barrier
    s_cmp_lg_u32 s40, 7
    s_cbranch_scc1 L_38
    s_lshl_b32 s52, s47, 2
    s_add_u32 s52, s52, s48
    s_lshl_b32 s52, s52, 6
    s_add_u32 s52, s52, 8298496
    v_mov_b32 v10, 0
    s_mov_b64 exec, 1
    buffer_store_dword v10, v10, s[20:23], s52 offen sc1
    s_mov_b64 exec, -1
L_38:
    s_branch L_fin
L_37:
    v_lshrrev_b32 v20, 4, v1
    v_bfe_u32 v21, v0, 2, 2
    v_and_b32 v22, 3, v0
    v_lshl_add_u32 v11, v20, 2, v21
    v_mul_u32_u24 v11, 928, v11
    v_lshl_add_u32 v11, v22, 3, v11
    s_lshl_b32 s52, s40, 7
    s_add_u32 s52, s52, 131072
    v_add_u32 v11, s52, v11
    v_lshl_add_u32 v10, v20, 3, v21
    v_lshlrev_b32 v10, 6, v10
    s_bfe_u32 s52, s40, 0x10001
    v_and_b32 v14, 1, v20
    v_xor_b32 v14, s52, v14
    v_lshl_add_u32 v10, v14, 5, v10
    v_lshl_add_u32 v10, v22, 3, v10
    s_and_b32 s52, s40, 1
    s_lshl_b32 s53, s42, 1
    s_add_u32 s52, s52, s53
    s_mul_i32 s52, s52, 14336
    s_add_u32 s52, s52, 65536
    v_add_u32 v10, s52, v10
    ds_read_b64_tr_b16 v[200:201], v10 offset:0
    ds_read_b64_tr_b16 v[202:203], v10 offset:256
    ds_read_b64_tr_b16 v[204:205], v10 offset:2048
    ds_read_b64_tr_b16 v[206:207], v10 offset:2304
    ds_read_b64_tr_b16 v[208:209], v10 offset:4096
    ds_read_b64_tr_b16 v[210:211], v10 offset:4352
    ds_read_b64_tr_b16 v[212:213], v10 offset:6144
    ds_read_b64_tr_b16 v[214:215], v10 offset:6400
    ds_read_b64_tr_b16 v[216:217], v10 offset:8192
    ds_read_b64_tr_b16 v[218:219], v10 offset:8448
    ds_read_b64_tr_b16 v[220:221], v10 offset:10240
    ds_read_b64_tr_b16 v[222:223], v10 offset:10496
    ds_read_b64_tr_b16 v[224:225], v10 offset:12288
    ds_read_b64_tr_b16 v[226:227], v10 offset:12544
    v_mov_b32 v12, 0x3f803f80
    v_mov_b32 v13, v12
    v_mov_b32 v14, v12
    v_mov_b32 v15, v12
    ds_write_b128 v2, v[12:15] offset:23808
    s_waitcnt lgkmcnt(6)
    ds_read_b64_tr_b16 v[232:233], v11 offset:0
    ds_read_b64_tr_b16 v[234:235], v11 offset:14848
    ds_read_b64_tr_b16 v[236:237], v11 offset:32
    ds_read_b64_tr_b16 v[238:239], v11 offset:14880
    ds_read_b64_tr_b16 v[240:241], v11 offset:64
    ds_read_b64_tr_b16 v[242:243], v11 offset:14912
    ds_read_b64_tr_b16 v[244:245], v11 offset:96
    ds_read_b64_tr_b16 v[246:247], v11 offset:14944
    v_mov_b32 v14, 160768
    v_lshl_add_u32 v13, s40, 2, v14
    v_mov_b32 v15, 4
    v_mov_b32 v16, 122880
    v_lshl_add_u32 v17, v3, 2, v16
    v_lshl_add_u32 v16, v4, 6, v16
    v_mov_b32 v116, 0
    v_lshrrev_b32 v10, 3, v1
    v_lshlrev_b32 v10, 10, v10
    v_lshl_add_u32 v10, s40, 7, v10
    v_and_b32 v21, 15, v0
    v_and_b32 v22, 7, v0
    v_mul_u32_u24 v23, 928, v22
    v_lshl_add_u32 v19, v22, 4, v10
    s_mul_i32 s52, s40, 928
    v_add_u32 v18, s52, v2
    s_mul_i32 s61, s50, 37
    s_lshr_b32 s61, s61, 9
    s_lshl_b32 s61, s61, 6
    s_add_u32 s61, s61, 8298496
    v_cmp_eq_u32 vcc, 8, v21
    v_mov_b32 v10, 7424
    s_and_b32 s51, s40, 1
    s_mul_i32 s54, s51, 448
    v_cndmask_b32 v10, v23, v10, vcc
    v_lshl_add_u32 v10, v20, 4, v10
    v_add_u32 v117, s54, v10
    s_bfe_u32 s54, s40, 0x10001
    s_lshl_b32 s54, s54, 12
    s_lshl_b32 s3, s42, 3
    s_add_u32 s54, s54, s3
    s_lshl_b32 s3, s51, 2
    s_add_u32 s54, s54, s3
    v_lshlrev_b32 v12, 10, v20
    v_lshl_add_u32 v12, v21, 4, v12
    v_add_u32 v118, s54, v12
    v_lshlrev_b32 v12, 12, v4
    v_bfe_u32 v10, v0, 3, 2
    v_lshl_add_u32 v12, v10, 8, v12
    v_lshl_add_u32 v119, s40, 10, v12
    v_lshl_add_u32 v120, v22, 4, v119
    v_lshlrev_b32 v10, 4, v22
    v_lshl_add_u32 v122, v20, 7, v10
    v_lshl_add_u32 v10, v20, 2, v10
    v_lshl_add_u32 v121, s40, 7, v10
    v_lshlrev_b32 v12, 5, v22
    v_bfe_u32 v10, v0, 4, 1
    v_lshl_add_u32 v12, v10, 4, v12
    v_mul_u32_u24 v10, 14336, v4
    v_add_u32 v123, v12, v10
    s_mul_i32 s62, s40, 114688
    s_lshl_b32 s53, s50, 8
    s_add_u32 s62, s62, s53
    s_add_u32 s62, s62, 10485760
    s_cmp_eq_u32 s40, 7
    s_cselect_b32 s62, 0x40000000, s62
    s_mov_b32 s52, 8257536
    s_mov_b32 s55, 0x20000
    s_waitcnt vmcnt(0)
L_41:
    buffer_load_dwordx4 v[104:107], v19, s[20:23], s52 offen sc1
    s_sub_u32 s55, s55, 1
    s_waitcnt vmcnt(0)
    s_cbranch_scc1 L_42
    v_max3_u32 v11, v104, v105, v106
    v_max_u32 v11, v11, v107
    v_cmp_eq_u32 vcc, -1, v11
    s_cbranch_vccnz L_41
L_42:
    v_max_u32_dpp v11, v11, v11 quad_perm:[1,0,3,2] row_mask:0xf bank_mask:0xf
    s_nop 1
    v_max_u32_dpp v11, v11, v11 quad_perm:[2,3,0,1] row_mask:0xf bank_mask:0xf
    s_nop 1
    v_max_u32_dpp v11, v11, v11 row_half_mirror row_mask:0xf bank_mask:0xf
    s_nop 1
    v_max_u32_dpp v11, v11, v11 row_mirror row_mask:0xf bank_mask:0xf
    v_mov_b32 v12, v11
    s_nop 1
    v_permlane16_swap_b32 v11, v12
    v_max_u32 v11, v11, v12
    v_mov_b32 v12, v11
    s_nop 1
    v_permlane32_swap_b32 v11, v12
    v_max_u32 v11, v11, v12
    ds_write_b32 v13, v11
    s_waitcnt lgkmcnt(0)
    s_barrier
    ds_read_b128 v[108:111], v14
    ds_read_b128 v[112:115], v14 offset:16
    s_waitcnt lgkmcnt(0)
    v_min3_u32 v108, v108, v109, v110
    v_min3_u32 v112, v112, v113, v114
    v_min3_u32 v108, v108, v111, v115
    v_min_u32 v108, v108, v112
    v_cmp_le_u32 s[64:65], v108, v104
    v_cmp_le_u32 s[66:67], v108, v105
    v_cmp_le_u32 s[68:69], v108, v106
    v_cmp_le_u32 s[70:71], v108, v107
    s_mov_b64 exec, s[64:65]
    ds_add_rtn_u32 v112, v14, v15 offset:32
    s_mov_b64 exec, s[66:67]
    ds_add_rtn_u32 v113, v14, v15 offset:32
    s_mov_b64 exec, s[68:69]
    ds_add_rtn_u32 v114, v14, v15 offset:32
    s_mov_b64 exec, s[70:71]
    ds_add_rtn_u32 v115, v14, v15 offset:32
    s_waitcnt lgkmcnt(0)
    s_mov_b64 exec, s[64:65]
    ds_write_b32 v112, v104
    s_mov_b64 exec, s[66:67]
    ds_write_b32 v113, v105
    s_mov_b64 exec, s[68:69]
    ds_write_b32 v114, v106
    s_mov_b64 exec, s[70:71]
    ds_write_b32 v115, v107
    s_mov_b64 exec, -1
    s_waitcnt lgkmcnt(0)
    s_barrier
    ds_read_b32 v104, v17
    ds_read_b128 v[24:27], v16 offset:0
    ds_read_b128 v[28:31], v16 offset:16
    ds_read_b128 v[32:35], v16 offset:32
    ds_read_b128 v[36:39], v16 offset:48
    ds_read_b32 v11, v14 offset:32
    s_waitcnt lgkmcnt(3)
    v_cmp_gt_u32 s[64:65], v24, v104
    v_cmp_gt_u32 s[66:67], v25, v104
    v_cmp_gt_u32 s[68:69], v26, v104
    v_cmp_gt_u32 s[70:71], v27, v104
    v_cmp_gt_u32 s[72:73], v28, v104
    v_cmp_gt_u32 s[74:75], v29, v104
    v_cmp_gt_u32 s[76:77], v30, v104
    v_cmp_gt_u32 s[78:79], v31, v104
    v_addc_co_u32 v116, vcc, 0, v116, s[64:65]
    v_addc_co_u32 v116, vcc, 0, v116, s[66:67]
    v_addc_co_u32 v116, vcc, 0, v116, s[68:69]
    v_addc_co_u32 v116, vcc, 0, v116, s[70:71]
    v_addc_co_u32 v116, vcc, 0, v116, s[72:73]
    v_addc_co_u32 v116, vcc, 0, v116, s[74:75]
    v_addc_co_u32 v116, vcc, 0, v116, s[76:77]
    v_addc_co_u32 v116, vcc, 0, v116, s[78:79]
    s_waitcnt lgkmcnt(1)
    v_cmp_gt_u32 s[64:65], v32, v104
    v_cmp_gt_u32 s[66:67], v33, v104
    v_cmp_gt_u32 s[68:69], v34, v104
    v_cmp_gt_u32 s[70:71], v35, v104
    v_cmp_gt_u32 s[72:73], v36, v104
    v_cmp_gt_u32 s[74:75], v37, v104
    v_cmp_gt_u32 s[76:77], v38, v104
    v_cmp_gt_u32 s[78:79], v39, v104
    v_addc_co_u32 v116, vcc, 0, v116, s[64:65]
    v_addc_co_u32 v116, vcc, 0, v116, s[66:67]
    v_addc_co_u32 v116, vcc, 0, v116, s[68:69]
    v_addc_co_u32 v116, vcc, 0, v116, s[70:71]
    v_addc_co_u32 v116, vcc, 0, v116, s[72:73]
    v_addc_co_u32 v116, vcc, 0, v116, s[74:75]
    v_addc_co_u32 v116, vcc, 0, v116, s[76:77]
    v_addc_co_u32 v116, vcc, 0, v116, s[78:79]
    v_mov_b32 v12, v116
    s_waitcnt lgkmcnt(0)
    v_readfirstlane_b32 s51, v11
    v_permlane32_swap_b32 v116, v12
    v_add_u32 v116, v116, v12
    v_cmp_eq_u32 vcc, s40, v116
    s_cmp_gt_u32 s51, 123008
    s_cbranch_scc1 L_43
L_46:
    s_ff1_i32_b64 s52, vcc
    v_readlane_b32 s51, v104, s52
    s_mov_b32 s55, 0x20000
    s_andn2_b32 s51, 2047, s51
    s_mul_i32 s52, s51, 896
    s_add_u32 s52, s52, 6291456
    v_add_u32 v105, s52, v2
    s_lshl_b32 s52, s51, 4
    s_add_u32 s52, s52, 8265728
    v_writelane_b32 v105, s52, 56
    s_mov_b32 exec_hi, 0x1ffffff
L_47:
    buffer_load_dwordx4 v[108:111], v105, s[20:23], 0 offen sc1
L_47_:
    s_lshr_b32 s58, s51, 5
    s_lshl_b32 s58, s58, 8
    s_add_u32 s58, s58, s61
    s_sub_u32 s55, s55, 1
    s_waitcnt vmcnt(0) lgkmcnt(0)
    ds_write_b128 v18, v[108:111] offset:16384
    s_cbranch_scc1 L_48
    v_max3_u32 v10, v108, v109, v110
    v_max_u32 v10, v10, v111
    v_cmp_eq_u32 vcc, -1, v10
    s_cbranch_vccnz L_47__
L_48:
    s_mov_b32 exec_hi, -1
    s_cmp_lg_u32 s40, 7
    s_cbranch_scc1 L_49
    s_lshl_b32 s52, s47, 2
    s_add_u32 s52, s52, s48
    s_lshl_b32 s52, s52, 6
    s_add_u32 s52, s52, 8298496
    v_mov_b32 v10, 0
    s_mov_b64 exec, 1
    buffer_store_dword v10, v10, s[20:23], s52 offen sc1
    s_mov_b64 exec, -1
L_49:
    s_waitcnt lgkmcnt(0)
    s_barrier
    ds_read_b128 v[24:27], v117 offset:16384
    ds_read_b128 v[28:31], v117 offset:16448
    ds_read_b128 v[32:35], v117 offset:16512
    ds_read_b128 v[36:39], v117 offset:16576
    ds_read_b128 v[40:43], v117 offset:16640
    ds_read_b128 v[44:47], v117 offset:16704
    ds_read_b128 v[48:51], v117 offset:16768
    v_mov_b32 v11, 0
    buffer_load_dword v62, v11, s[20:23], s58 offen sc1
    ds_read_b64 v[80:81], v23 offset:17280
    s_waitcnt lgkmcnt(7)
    v_mfma_f32_16x16x32_bf16 v[84:87], v[200:203], v[24:27], 0
    s_waitcnt lgkmcnt(6)
    v_mfma_f32_16x16x32_bf16 v[84:87], v[204:207], v[28:31], v[84:87]
    s_waitcnt lgkmcnt(5)
    v_mfma_f32_16x16x32_bf16 v[84:87], v[208:211], v[32:35], v[84:87]
    s_waitcnt lgkmcnt(4)
    v_mfma_f32_16x16x32_bf16 v[84:87], v[212:215], v[36:39], v[84:87]
    s_waitcnt lgkmcnt(3)
    v_mfma_f32_16x16x32_bf16 v[84:87], v[216:219], v[40:43], v[84:87]
    s_waitcnt lgkmcnt(2)
    v_mfma_f32_16x16x32_bf16 v[84:87], v[220:223], v[44:47], v[84:87]
    s_waitcnt lgkmcnt(1)
    v_mfma_f32_16x16x32_bf16 v[84:87], v[224:227], v[48:51], v[84:87]
    s_mov_b32 exec_lo, 0x01ff01ff
    s_mov_b32 exec_hi, 0x01ff01ff
    s_nop 5
    ds_write_b32 v118, v84 offset:0
    ds_write_b32 v118, v85 offset:256
    ds_write_b32 v118, v86 offset:512
    ds_write_b32 v118, v87 offset:768
    s_mov_b64 exec, -1
    s_waitcnt lgkmcnt(0)
    s_barrier
    s_cmp_lt_u32 s40, 4
    s_cbranch_scc0 L_actd
    ds_read_b128 v[88:91], v120
    ds_read_b128 v[92:95], v119 offset:128
    s_waitcnt lgkmcnt(0)
    v_add_f32 v88, v88, v89
    v_add_f32 v92, v92, v93
    v_add_f32 v89, v90, v91
    v_add_f32 v93, v94, v95
    v_fma_f32 v88, -v80, v92, v88
    v_fma_f32 v89, -v80, v93, v89
    v_mul_f32 v88, v88, v81
    v_mul_f32 v89, v89, v81
    v_cvt_pk_bf16_f32 v88, v88, v89
    v_and_b32 v89, 0xffff0000, v88
    v_lshlrev_b32 v88, 16, v88
    v_mul_f32 v90, 0xbfb8aa3b, v88
    v_exp_f32 v90, v90
    s_nop 0
    v_add_f32 v90, 1.0, v90
    v_rcp_f32 v90, v90
    s_nop 0
    v_mul_f32 v88, v88, v90
    v_cvt_pk_bf16_f32 v88, v88, v88
    v_and_b32 v88, 0xffff0000, v88
    v_mul_f32 v88, v88, v89
    s_nop 1
    v_mov_b32_dpp v89, v88 row_ror:8 row_mask:0xf bank_mask:0xf
    v_cvt_pk_bf16_f32 v88, v88, v89
    s_mov_b32 exec_lo, 0x00ff00ff
    s_mov_b32 exec_hi, 0x00ff00ff
    ds_write_b32 v121, v88 offset:8192
    s_mov_b64 exec, -1
L_actd:
    s_waitcnt lgkmcnt(0)
    s_barrier
    ds_read_b128 v[88:91], v122 offset:8192
    s_add_u32 s53, s62, 28672
    s_add_u32 s54, s62, 57344
    s_add_u32 s51, s62, 86016
    s_waitcnt lgkmcnt(0)
    v_mfma_f32_16x16x32_bf16 v[24:27], v[232:235], v[88:91], 0
    v_mfma_f32_16x16x32_bf16 v[28:31], v[236:239], v[88:91], 0
    v_mfma_f32_16x16x32_bf16 v[32:35], v[240:243], v[88:91], 0
    v_mfma_f32_16x16x32_bf16 v[36:39], v[244:247], v[88:91], 0
    s_mov_b32 exec_lo, 0x00ff00ff
    s_mov_b32 exec_hi, 0x00ff00ff
    s_nop 2
    buffer_store_dwordx4 v[24:27], v123, s[20:23], s62 offen sc1
    buffer_store_dwordx4 v[28:31], v123, s[20:23], s53 offen sc1
    buffer_store_dwordx4 v[32:35], v123, s[20:23], s54 offen sc1
    buffer_store_dwordx4 v[36:39], v123, s[20:23], s51 offen sc1
    s_mov_b64 exec, -1
    s_mul_i32 s52, s50, 14336
    s_lshl_b32 s53, s40, 11
    s_add_u32 s52, s52, s53
    s_add_u32 s52, s52, 10485760
    s_cmp_eq_u32 s40, 7
    s_cselect_b32 s52, 0x40000000, s52
    s_cmp_lg_u32 s40, 0
    s_cbranch_scc1 L_52
    v_bfe_u32 v10, v0, 1, 3
    v_mul_u32_u24 v10, 928, v10
    v_and_b32 v105, 1, v0
    s_lshl_b32 s53, s50, 4
    v_lshl_add_u32 v105, v105, 3, s53
    v_add_u32 v13, v10, v105
    ds_read_b64 v[60:61], v13 offset:16384
    ds_read_b128 v[80:83], v10 offset:17280
    s_waitcnt lgkmcnt(0)
    v_mul_u32_u24 v10, 896, v83
    v_add_u32 v105, v105, v10
    v_lshlrev_b32 v64, 16, v60
    v_and_b32 v65, 0xffff0000, v60
    v_lshlrev_b32 v66, 16, v61
    v_and_b32 v67, 0xffff0000, v61
    v_pk_add_f32 v[68:69], v[64:65], v[80:81] op_sel_hi:[1,0] neg_lo:[0,1] neg_hi:[0,1]
    v_pk_add_f32 v[70:71], v[66:67], v[80:81] op_sel_hi:[1,0] neg_lo:[0,1] neg_hi:[0,1]
    v_cvt_pk_bf16_f32 v68, v68, v69
    v_cvt_pk_bf16_f32 v70, v70, v71
    v_and_b32 v69, 0xffff0000, v68
    v_lshlrev_b32 v68, 16, v68
    v_and_b32 v71, 0xffff0000, v70
    v_lshlrev_b32 v70, 16, v70
    v_pk_mul_f32 v[68:69], v[68:69], v[80:81] op_sel:[0,1] op_sel_hi:[1,1]
    v_pk_mul_f32 v[70:71], v[70:71], v[80:81] op_sel:[0,1] op_sel_hi:[1,1]
    v_cvt_pk_bf16_f32 v68, v68, v69
    v_cvt_pk_bf16_f32 v70, v70, v71
    v_and_b32 v69, 0xffff0000, v68
    v_lshlrev_b32 v68, 16, v68
    v_and_b32 v71, 0xffff0000, v70
    v_lshlrev_b32 v70, 16, v70
L_52:
    s_mov_b32 s55, 0x20000
L_50:
    s_sub_u32 s55, s55, 1
    s_waitcnt vmcnt(0)
    s_cbranch_scc1 L_51
    v_cmp_eq_u32 vcc, -1, v62
    s_cbranch_vccz L_51
    buffer_load_dword v62, v11, s[20:23], s58 offen sc1
    s_branch L_50
L_51:
    s_mov_b32 s55, 0x20000
L_53:
    buffer_load_dwordx4 v[40:43], v2, s[20:23], s52 offen sc1
    buffer_load_dwordx4 v[44:47], v2, s[20:23], s52 offen offset:1024 sc1
    s_sub_u32 s55, s55, 1
    s_waitcnt vmcnt(0) lgkmcnt(0)
    v_pk_add_f32 v[84:85], v[40:41], v[44:45]
    v_pk_add_f32 v[86:87], v[42:43], v[46:47]
    ds_write_b128 v71, v[84:87]
    s_cbranch_scc1 L_54
    v_max3_u32 v10, v40, v41, v42
    v_max3_u32 v12, v43, v44, v45
    v_max3_u32 v10, v10, v46, v47
    v_max_u32 v10, v10, v12
    v_cmp_eq_u32 vcc, -1, v10
    s_cbranch_vccnz L_53
L_54:
    s_waitcnt lgkmcnt(0)
    s_barrier
    s_cmp_lg_u32 s40, 0
    s_cbranch_scc1 L_fin
    ds_read_b128 v[28:31], v2 offset:1024
    ds_read_b128 v[32:35], v2 offset:2048
    ds_read_b128 v[36:39], v2 offset:3072
    ds_read_b128 v[40:43], v2 offset:4096
    ds_read_b128 v[44:47], v2 offset:5120
    ds_read_b128 v[48:51], v2 offset:6144
    s_waitcnt lgkmcnt(3)
    v_pk_add_f32 v[84:85], v[84:85], v[28:29]
    v_pk_add_f32 v[86:87], v[86:87], v[30:31]
    v_pk_add_f32 v[32:33], v[32:33], v[36:37]
    v_pk_add_f32 v[34:35], v[34:35], v[38:39]
    v_pk_add_f32 v[84:85], v[84:85], v[32:33]
    v_pk_add_f32 v[86:87], v[86:87], v[34:35]
    s_waitcnt lgkmcnt(0)
    v_pk_add_f32 v[40:41], v[40:41], v[44:45]
    v_pk_add_f32 v[42:43], v[42:43], v[46:47]
    v_pk_add_f32 v[84:85], v[84:85], v[48:49]
    v_pk_add_f32 v[86:87], v[86:87], v[50:51]
    v_pk_add_f32 v[84:85], v[84:85], v[40:41]
    v_pk_add_f32 v[86:87], v[86:87], v[42:43]
    v_mov_b32 v88, v84
    v_mov_b32 v89, v85
    v_mov_b32 v90, v86
    v_mov_b32 v91, v87
    v_permlane32_swap_b32 v84, v88
    v_permlane32_swap_b32 v85, v89
    v_permlane32_swap_b32 v86, v90
    v_permlane32_swap_b32 v87, v91
    v_pk_add_f32 v[84:85], v[84:85], v[88:89]
    v_pk_add_f32 v[86:87], v[86:87], v[90:91]
    v_mov_b32 v88, v84
    v_mov_b32 v89, v85
    v_mov_b32 v90, v86
    v_mov_b32 v91, v87
    v_permlane16_swap_b32 v84, v88
    v_permlane16_swap_b32 v85, v89
    v_permlane16_swap_b32 v86, v90
    v_permlane16_swap_b32 v87, v91
    v_pk_add_f32 v[84:85], v[84:85], v[88:89]
    v_pk_add_f32 v[86:87], v[86:87], v[90:91]
    v_cvt_pk_bf16_f32 v84, v84, v85
    v_cvt_pk_bf16_f32 v86, v86, v87
    v_and_b32 v85, 0xffff0000, v84
    v_lshlrev_b32 v84, 16, v84
    v_and_b32 v87, 0xffff0000, v86
    v_lshlrev_b32 v86, 16, v86
    v_pk_mul_f32 v[84:85], v[84:85], v[82:83] op_sel_hi:[1,0]
    v_pk_mul_f32 v[86:87], v[86:87], v[82:83] op_sel_hi:[1,0]
    v_cvt_pk_bf16_f32 v84, v84, v85
    v_cvt_pk_bf16_f32 v86, v86, v87
    v_and_b32 v85, 0xffff0000, v84
    v_lshlrev_b32 v84, 16, v84
    v_and_b32 v87, 0xffff0000, v86
    v_lshlrev_b32 v86, 16, v86
    v_pk_add_f32 v[84:85], v[84:85], v[68:69]
    v_pk_add_f32 v[86:87], v[86:87], v[70:71]
    v_cvt_pk_bf16_f32 v84, v84, v85
    v_cvt_pk_bf16_f32 v86, v86, v87
    v_and_b32 v85, 0xffff0000, v84
    v_lshlrev_b32 v84, 16, v84
    v_and_b32 v87, 0xffff0000, v86
    v_lshlrev_b32 v86, 16, v86
    v_pk_add_f32 v[84:85], v[84:85], v[64:65]
    v_pk_add_f32 v[86:87], v[86:87], v[66:67]
    v_cvt_pk_bf16_f32 v12, v84, v85
    v_cvt_pk_bf16_f32 v13, v86, v87
    s_mov_b64 exec, 0xffff
    buffer_store_dwordx2 v[12:13], v105, s[24:27], 0 offen sc1
    s_mov_b64 exec, -1
    s_branch L_fin
L_17:
    s_mov_b32 s54, 0x20000
    s_mov_b32 s53, 8388612
L_17_:
    buffer_load_dword v70, v16, s[20:23], s53 offen sc1
    s_waitcnt vmcnt(0)
    v_cmp_gt_u32 vcc, 16, v70
    s_sub_u32 s54, s54, 1
    s_cbranch_scc1 L_18
    s_and_b32 vcc_lo, vcc_lo, 0xffff
    s_cbranch_scc1 L_17_
    s_branch L_18
L_20:
    s_mov_b32 s54, 0x20000
    s_mov_b32 s53, 8388612
L_20_:
    buffer_load_dword v70, v16, s[20:23], s53 offen sc1
    s_waitcnt vmcnt(0)
    v_cmp_gt_u32 vcc, 16, v70
    s_sub_u32 s54, s54, 1
    s_cbranch_scc1 L_21
    s_and_b32 vcc_lo, vcc_lo, 0xffff
    s_cbranch_scc1 L_20_
    s_branch L_21
L_23:
    s_mov_b32 s54, 0x20000
    s_mov_b32 s53, 8388612
L_23_:
    buffer_load_dword v70, v16, s[20:23], s53 offen sc1
    s_waitcnt vmcnt(0)
    v_cmp_gt_u32 vcc, 16, v70
    s_sub_u32 s54, s54, 1
    s_cbranch_scc1 L_24
    s_and_b32 vcc_lo, vcc_lo, 0xffff
    s_cbranch_scc1 L_23_
    s_branch L_24
L_28:
    s_mov_b32 s54, 0x20000
    s_mov_b32 s53, 8388612
L_28_:
    buffer_load_dword v70, v16, s[20:23], s53 offen sc1
    s_waitcnt vmcnt(0)
    v_cmp_gt_u32 vcc, 16, v70
    s_sub_u32 s54, s54, 1
    s_cbranch_scc1 L_29
    s_and_b32 vcc_lo, vcc_lo, 0xffff
    s_cbranch_scc1 L_28_
    s_branch L_29
L_47__:
    s_waitcnt lgkmcnt(0)
    s_branch L_47
L_43:
    s_mov_b32 s52, 122880
    v_lshl_add_u32 v17, v1, 2, s52
L_44:
    ds_read_b32 v104, v17
    v_mov_b32 v13, 122880
    v_mov_b32 v116, 0
    s_mov_b32 s53, 122880
L_45:
    ds_read_b128 v[24:27], v13
    ds_read_b128 v[28:31], v13 offset:16
    v_add_u32 v13, 32, v13
    s_add_u32 s53, s53, 32
    s_waitcnt lgkmcnt(0)
    v_cmp_gt_u32 s[64:65], v24, v104
    v_cmp_gt_u32 s[66:67], v25, v104
    v_cmp_gt_u32 s[68:69], v26, v104
    v_cmp_gt_u32 s[70:71], v27, v104
    v_cmp_gt_u32 s[72:73], v28, v104
    v_cmp_gt_u32 s[74:75], v29, v104
    v_cmp_gt_u32 s[76:77], v30, v104
    v_cmp_gt_u32 s[78:79], v31, v104
    v_addc_co_u32 v116, vcc, 0, v116, s[64:65]
    v_addc_co_u32 v116, vcc, 0, v116, s[66:67]
    v_addc_co_u32 v116, vcc, 0, v116, s[68:69]
    v_addc_co_u32 v116, vcc, 0, v116, s[70:71]
    v_addc_co_u32 v116, vcc, 0, v116, s[72:73]
    v_addc_co_u32 v116, vcc, 0, v116, s[74:75]
    v_addc_co_u32 v116, vcc, 0, v116, s[76:77]
    v_addc_co_u32 v116, vcc, 0, v116, s[78:79]
    s_cmp_lt_u32 s53, s51
    s_cbranch_scc1 L_45
    v_cmp_eq_u32 vcc, s40, v116
    v_add_u32 v17, 256, v17
    s_add_u32 s52, s52, 256
    s_cbranch_vccnz L_46
    s_cmp_lt_u32 s52, s51
    s_cbranch_scc1 L_44
    s_branch L_46
L_fallback:
    s_waitcnt lgkmcnt(0)
    v_cndmask_b32 v96, v96, 0, s[66:67]
    v_cndmask_b32 v97, v97, 0, s[66:67]
    v_cndmask_b32 v102, v102, 0, s[64:65]
    v_cndmask_b32 v103, v103, 0, s[64:65]
    s_lshl_b32 s52, s43, 18
    s_lshl_b32 s53, s42, 13
    s_add_u32 s52, s52, s53
    s_mov_b32 s53, 0
    v_mov_b32 v19, 0xff800000
L_55:
    buffer_load_dwordx4 v[168:171], v2, s[20:23], s52 offen sc1
    buffer_load_dwordx4 v[172:175], v2, s[20:23], s52 offen offset:1024 sc1
    s_waitcnt vmcnt(0)
    v_mfma_f32_32x32x16_bf16 v[104:119], v[168:171], v[96:99], 0
    v_mfma_f32_32x32x16_bf16 v[104:119], v[172:175], v[100:103], v[104:119]
    s_and_b32 s54, s53, 1
    s_mul_i32 s54, s54, 8192
    s_add_u32 s52, s52, s54
    s_add_u32 s52, s52, 4096
    s_add_u32 s53, s53, 1
    s_nop 7
    v_max3_f32 v19, v19, v104, v105
    v_max3_f32 v19, v19, v106, v107
    v_max3_f32 v19, v19, v108, v109
    v_max3_f32 v19, v19, v110, v111
    v_max3_f32 v19, v19, v112, v113
    v_max3_f32 v19, v19, v114, v115
    v_max3_f32 v19, v19, v116, v117
    v_max3_f32 v19, v19, v118, v119
    s_cmp_lt_u32 s53, 32
    s_cbranch_scc1 L_55
    v_mov_b32 v11, v19
    s_mov_b32 s63, 1
    s_nop 0
    v_permlane32_swap_b32 v19, v11
    v_max_f32 v19, v19, v11
    s_barrier
    s_add_u32 m0, s56, 49152
    s_mov_b32 s51, s58
    buffer_load_dwordx4 v5, s[20:23], s51 offen offset:0 sc1 lds
    buffer_load_dwordx4 v5, s[20:23], s51 offen offset:1024 sc1 lds
    s_mov_b32 m0, s56
    s_xor_b32 s51, s58, 16384
    buffer_load_dwordx4 v5, s[20:23], s51 offen offset:0 sc1 lds
    buffer_load_dwordx4 v5, s[20:23], s51 offen offset:1024 sc1 lds
    s_add_u32 m0, s56, 16384
    s_xor_b32 s51, s58, 32768
    buffer_load_dwordx4 v5, s[20:23], s51 offen offset:0 sc1 lds
    buffer_load_dwordx4 v5, s[20:23], s51 offen offset:1024 sc1 lds
    s_branch L_attn
L_fin:
L_end:
    s_endpgm

.section .rodata,"a"
.p2align 6
.amdhsa_kernel sequential_preLN__mha_block__moe_arch_mod__prompt_kernel
  .amdhsa_next_free_vgpr 248
  .amdhsa_next_free_sgpr 102
  .amdhsa_accum_offset 248
  .amdhsa_group_segment_fixed_size 0
  .amdhsa_kernarg_size 88
  .amdhsa_user_sgpr_count 2
  .amdhsa_user_sgpr_kernarg_segment_ptr 1
  .amdhsa_system_sgpr_workgroup_id_x 1
  .amdhsa_float_denorm_mode_32 3
.end_amdhsa_kernel
```
